```python
import torch

def _softmax(x, axis=-1):
    return torch.softmax(x, dim=axis)
def _gelu(x):
    return torch.nn.functional.gelu(x, approximate="tanh")
def _silu(x):
    return torch.nn.functional.silu(x)
def _sigmoid(x):
    return torch.sigmoid(x)
def _layernorm(x, axis=-1, eps=1e-5):
    m = x.mean(dim=axis, keepdim=True)
    v = x.var(dim=axis, keepdim=True, unbiased=False)
    return (x - m) / torch.sqrt(v + eps)
def _scatter_add(tgt, idx, src, axis=0):
    return tgt.clone().index_add_(axis, idx, src)
def _segment_sum(src, seg, n):
    out = torch.zeros((n,) + src.shape[1:], dtype=src.dtype)
    return out.index_add_(0, seg, src)
def _pad(x, pw):
    flat = tuple(v for pair in reversed(pw) for v in pair)
    return torch.nn.functional.pad(x, flat)

kernel_name = 'concat_heads__mha_block_cached__gqa_block_cached__near_ridge'

def setup_inputs():

    _w = (lambda a: (lambda t: t.to(torch.bfloat16) if t.is_floating_point() else t)(torch.as_tensor(a)))
    def _A_setup():
        B, Sq, D = 8, 96, 640
        H, Sk, Dh = 32, 96, 128
        return {
            "x": _w((lambda *s: torch.randn(*s, dtype=torch.bfloat16) * 0.8)(B, Sq, D)),
            "k_cache": _w((lambda *s: torch.randn(*s, dtype=torch.bfloat16) * 0.8)(B, H, Sk, Dh)),
            "v_cache": _w((lambda *s: torch.randn(*s, dtype=torch.bfloat16) * 0.05)(B, H, Sk, Dh)),
            "wq": _w((lambda *s: torch.randn(*s, dtype=torch.bfloat16) * 0.8)(D, H * Dh) * (D ** -0.5)),
            "wo": _w((lambda *s: torch.randn(*s, dtype=torch.bfloat16) * 0.05)(H * Dh, D) * ((H * Dh) ** -0.5)),
        }
    _A_in = _A_setup()

    def _B_setup():
        B, Sq, D = 8, 96, 640
        Hq, Hkv, Sk, Dh = 32, 32, 96, 128
        assert Hq % Hkv == 0, (Hq, Hkv)
        return {
            "x": _w((lambda *s: torch.randn(*s, dtype=torch.bfloat16) * 0.8)(B, Sq, D)),
            "k_cache": _w((lambda *s: torch.randn(*s, dtype=torch.bfloat16) * 0.8)(B, Hkv, Sk, Dh)),
            "v_cache": _w((lambda *s: torch.randn(*s, dtype=torch.bfloat16) * 0.05)(B, Hkv, Sk, Dh)),
            "wq": _w((lambda *s: torch.randn(*s, dtype=torch.bfloat16) * 0.8)(D, Hq * Dh) * (D ** -0.5)),
            "wo": _w((lambda *s: torch.randn(*s, dtype=torch.bfloat16) * 0.05)(Hq * Dh, D) * ((Hq * Dh) ** -0.5)),
        }
    _B_in = _B_setup()

    return {
        "A_x": _A_in["x"],
        "A_k_cache": _A_in["k_cache"],
        "A_v_cache": _A_in["v_cache"],
        "A_wq": _A_in["wq"],
        "A_wo": _A_in["wo"],
        "B_x": _B_in["x"],
        "B_k_cache": _B_in["k_cache"],
        "B_v_cache": _B_in["v_cache"],
        "B_wq": _B_in["wq"],
        "B_wo": _B_in["wo"],
    }

def reference(A_x, A_k_cache, A_v_cache, A_wq, A_wo, B_x, B_k_cache, B_v_cache, B_wq, B_wo):
    def _A_ref(x, k_cache, v_cache, wq, wo):
        B, Sq, D = x.shape
        H, Dh = 32, 128
        q = (lambda x, *d: x.permute(*d))((x @ wq).reshape(B, Sq, H, Dh), 0, 2, 1, 3)
        scores = torch.einsum("bhqd,bhkd->bhqk", q, k_cache) * (Dh ** -0.5)
        p = _softmax(scores, axis=-1)
        o = torch.einsum("bhqk,bhkd->bhqd", p, v_cache)
        return (lambda x, *d: x.permute(*d))(o, 0, 2, 1, 3).reshape(B, Sq, H * Dh) @ wo

    def _B_ref(x, k_cache, v_cache, wq, wo):
        B, Sq, D = x.shape
        Hq, Dh = 32, 128
        Hkv = k_cache.shape[1]
        rep = Hq // Hkv
        q = (lambda x, *d: x.permute(*d))((x @ wq).reshape(B, Sq, Hq, Dh), 0, 2, 1, 3)
        k = (lambda x, n, axis: torch.repeat_interleave(x, n, dim=axis))(k_cache, rep, axis=1)
        v = (lambda x, n, axis: torch.repeat_interleave(x, n, dim=axis))(v_cache, rep, axis=1)
        scores = torch.einsum("bhqd,bhkd->bhqk", q, k) * (Dh ** -0.5)
        p = _softmax(scores, axis=-1)
        o = torch.einsum("bhqk,bhkd->bhqd", p, v)
        return (lambda x, *d: x.permute(*d))(o, 0, 2, 1, 3).reshape(B, Sq, Hq * Dh) @ wo

    a = _A_ref(A_x, A_k_cache, A_v_cache, A_wq, A_wo)
    b = _B_ref(B_x, B_k_cache, B_v_cache, B_wq, B_wo)
    return torch.concatenate([a, b], axis=-1)
```

```asm
; @launch grid=(256,1,1) block=(512,1,1) lds=163840
.amdgcn_target "amdgcn-amd-amdhsa--gfx950"
.text
.globl concat_heads__mha_block_cached__gqa_block_cached__near_ridge_kernel
.p2align 12
.p2align 8
.type concat_heads__mha_block_cached__gqa_block_cached__near_ridge_kernel,@function
concat_heads__mha_block_cached__gqa_block_cached__near_ridge_kernel:
    s_and_b32 s3, s2, 4
    s_mul_i32 s3, s3, 10
    s_load_dwordx8 s[4:11], s[0:1], s3
    s_cmpk_ge_u32 s2, 256
    s_cbranch_scc1 L_exit
    s_lshr_b32 s86, s2, 3
    v_lshrrev_b32 v3, 3, v0
    v_mul_u32_u24 v3, 40, v3
    s_mul_i32 s24, s86, 1408
    s_getpc_b64 s[26:27]
    v_add_u32 v5, s24, v3
    global_load_dword v252, v5, s[26:27]
    v_readfirstlane_b32 s23, v0
    v_lshrrev_b32 v1, 4, v0
    v_xor_b32 v2, v1, v0
    v_and_b32 v2, 7, v2
    v_lshl_add_u32 v2, v3, 1, v2
    v_lshlrev_b32 v4, 1, v1
    v_bfi_b32 v4, 7, v4, v1
    v_xor_b32 v4, v4, v0
    v_and_b32 v4, 15, v4
    v_lshl_add_u32 v4, v1, 9, v4
    s_lshr_b32 s22, s2, 6
    s_and_b32 s21, s86, 7
    s_add_u32 s24, s86, s22
    s_lshl_b32 s24, s24, 2
    s_lshr_b32 s24, 0x37303730, s24
    s_and_b32 s24, s24, 15
    s_lshl_b32 s78, s24, 7
    s_mul_i32 s25, s22, 245760
    s_add_u32 s26, s25, s78
    s_and_b32 s83, s2, 3
    s_lshl3_add_u32 s21, s83, s21
    s_lshl4_add_u32 s27, s78, s21
    s_lshl_b32 s27, s27, 8
    s_lshl4_add_u32 m0, s23, 73728
    v_lshl_add_u32 v4, v4, 4, s27
    s_waitcnt lgkmcnt(0)
    global_load_lds_dwordx4 v4, s[10:11]
    s_addk_i32 m0, -24576
    v_lshl_add_u32 v2, v2, 4, s26
    global_load_lds_dwordx4 v2, s[4:5]
    s_addk_i32 m0, 8192
    v_add_u32 v2, 81920, v2
    global_load_lds_dwordx4 v2, s[4:5]
    s_addk_i32 m0, 8192
    v_add_u32 v2, 81920, v2
    global_load_lds_dwordx4 v2, s[4:5]
L_first:
    v_and_b32 v0, 63, v0
    s_load_dwordx2 s[12:13], s[0:1], s3 offset:32
    s_load_dwordx4 s[16:19], s[0:1], 80
    s_load_dwordx2 s[14:15], s[0:1], 96
    s_lshr_b32 s23, s23, 6
    s_bfe_u32 s20, s2, 0x10002
    s_mov_b32 s98, 0
    s_cmp_lt_u32 s23, 4
    s_cbranch_scc1 L_compute
    s_setprio 1
    s_add_u32 s28, s4, s25
    s_addc_u32 s29, s5, 0
    s_mov_b32 s30, 245760
    s_mov_b32 s31, 0x20000
    s_lshl_b32 s27, s21, 8
    s_sub_u32 s26, 5242880, s27
    s_add_u32 s32, s10, s27
    s_addc_u32 s33, s11, 0
    s_mov_b32 s34, s26
    s_mov_b32 s35, 0x20000
    s_sub_u32 s25, s23, 4
    s_lshl_b32 s80, s25, 10
    s_lshl_b32 s79, s78, 12
    s_add_u32 s26, s79, s27
    s_add_u32 s26, s26, 131072
    v_subrev_u32 v3, s26, v4
    s_mul_i32 s26, s22, 245760
    s_add_u32 s26, s26, s78
    s_add_u32 s26, s26, 204800
    v_subrev_u32 v2, s26, v2
    s_add_u32 m0, s80, 81920
    s_add_u32 s24, s79, 262144
    buffer_load_dwordx4 v3, s[32:35], s24 offen lds
    s_add_u32 m0, s80, 86016
    s_add_u32 s24, s79, 393216
    buffer_load_dwordx4 v3, s[32:35], s24 offen lds
    s_add_u32 s78, s78, 128
    s_cmp_eq_u32 s78, 1280
    s_cselect_b32 s78, 0, s78
    s_lshl_b32 s79, s78, 12
    s_add_u32 m0, s80, 0
    s_add_u32 s24, s78, 0
    buffer_load_dwordx4 v2, s[28:31], s24 offen lds
    s_add_u32 m0, s80, 4096
    s_add_u32 s24, s78, 40960
    buffer_load_dwordx4 v2, s[28:31], s24 offen lds
    s_add_u32 m0, s80, 8192
    s_add_u32 s24, s78, 81920
    buffer_load_dwordx4 v2, s[28:31], s24 offen lds
    s_add_u32 m0, s80, 12288
    s_add_u32 s24, s78, 122880
    buffer_load_dwordx4 v2, s[28:31], s24 offen lds
    s_add_u32 m0, s80, 16384
    s_add_u32 s24, s78, 163840
    buffer_load_dwordx4 v2, s[28:31], s24 offen lds
    s_add_u32 m0, s80, 20480
    s_add_u32 s24, s78, 204800
    buffer_load_dwordx4 v2, s[28:31], s24 offen lds
    s_add_u32 m0, s80, 90112
    s_add_u32 s24, s79, 0
    buffer_load_dwordx4 v3, s[32:35], s24 offen lds
    s_add_u32 m0, s80, 94208
    s_add_u32 s24, s79, 131072
    buffer_load_dwordx4 v3, s[32:35], s24 offen lds
    s_waitcnt lgkmcnt(0)
    s_lshr_b32 s27, s80, 8
    v_lshrrev_b32 v6, 4, v0
    v_and_b32 v10, 15, v0
    v_and_b32 v8, 7, v1
    v_lshlrev_b32 v8, 1, v8
    v_xor_b32 v8, v8, v10
    v_lshlrev_b32 v8, 4, v8
    v_add_u32 v9, s27, v6
    v_lshlrev_b32 v11, 8, v9
    v_add_u32 v4, v8, v11
    v_mul_u32_u24 v12, 1280, v9
    v_add_u32 v14, v8, v12
    v_xor_b32 v12, v9, v10
    v_lshlrev_b32 v12, 4, v12
    v_add_u32 v5, v12, v11
    s_lshl_b32 s24, s22, 6
    s_add_u32 s24, s24, s21
    s_mul_i32 s24, s24, 24576
    s_add_u32 s36, s6, s24
    s_addc_u32 s37, s7, 0
    s_mov_b32 s38, 811008
    s_mov_b32 s39, 0x20000
    s_add_u32 s40, s8, s24
    s_addc_u32 s41, s9, 0
    s_mov_b32 s42, 811008
    s_mov_b32 s43, 0x20000
    s_lshr_b32 s24, s86, 1
    s_add_u32 s24, s24, s22
    s_mul_i32 s26, s24, 86
    s_lshr_b32 s26, s26, 8
    s_mul_i32 s26, s26, 3
    s_sub_u32 s87, s24, s26
    s_mul_i32 s24, s80, 6
    v_min_u32 v26, 47, v0
    v_lshl_add_u32 v26, v26, 7, s24
    v_lshlrev_b32 v36, 4, v0
    s_add_u32 m0, s80, 98304
    s_add_u32 s24, s79, 262144
    buffer_load_dwordx4 v3, s[32:35], s24 offen lds
    s_add_u32 m0, s80, 102400
    s_add_u32 s24, s79, 393216
    buffer_load_dwordx4 v3, s[32:35], s24 offen lds
    s_waitcnt vmcnt(12)
    s_barrier
    s_mul_i32 s85, s86, 43
    s_lshr_b32 s85, s85, 8
    s_mul_i32 s25, s85, 6
    s_sub_u32 s84, s86, s25
    s_lshl_b32 s88, s23, 10
    s_mul_i32 s24, s20, 6
    s_add_u32 s24, s24, s84
    s_lshl_b32 s24, s24, 5
    s_add_u32 s24, s24, s83
    s_lshl_b32 s24, s24, 15
    s_add_u32 s44, s14, s24
    s_addc_u32 s45, s15, 0
    s_mov_b32 s46, 950272
    s_mov_b32 s47, 0x20000
    s_mul_i32 s24, s83, 1310720
    s_lshl_b32 s26, s85, 8
    s_add_u32 s24, s24, s26
    s_cmp_lt_u32 s86, 30
    s_cselect_b32 s26, 1309696, 0
    s_add_u32 s48, s12, s24
    s_addc_u32 s49, s13, 0
    s_mov_b32 s50, s26
    s_mov_b32 s51, 0x20000
    s_mul_i32 s24, s20, 30
    s_add_u32 s24, s24, s86
    s_lshl_b32 s24, s24, 17
    s_add_u32 s24, s24, s88
    s_add_u32 s24, s24, 16777216
    s_add_u32 s52, s14, s24
    s_addc_u32 s53, s15, 0
    s_mov_b32 s54, 123904
    s_mov_b32 s55, 0x20000
    s_lshl_b32 s24, s20, 16
    s_add_u32 s24, s24, 33554432
    s_add_u32 s64, s14, s24
    s_addc_u32 s65, s15, 0
    s_mov_b32 s66, 278528
    s_mov_b32 s67, 0x20000
    s_mul_i32 s91, s20, 4294909952
    s_add_u32 s91, s91, 262144
    s_and_b32 s25, s23, 3
    s_lshl_b32 s24, s22, 2
    s_add_u32 s24, s24, s25
    s_and_b32 s26, s21, 7
    s_mul_i32 s93, s24, 24
    s_add_u32 s93, s93, s26
    s_lshl_b32 s93, s93, 2
    s_lshl_b32 s27, s83, 11
    s_add_u32 s93, s93, s27
    s_add_u32 s93, s93, s91
    s_lshl3_add_u32 s24, s22, s26
    s_lshl2_add_u32 s24, s24, s25
    s_lshl_b32 s24, s24, 7
    s_lshl_b32 s27, s83, 14
    s_add_u32 s92, s24, s27
    s_and_b32 s25, s23, 4
    s_add_u32 s94, s24, s25
    s_lshl2_add_u32 s24, s84, s83
    s_mul_i32 s24, s24, 81920
    s_mul_i32 s25, s20, 40
    s_lshl3_add_u32 s25, s85, s25
    s_add_u32 s25, s25, s23
    s_lshl_b32 s25, s25, 5
    s_add_u32 s24, s24, s25
    s_add_u32 s56, s16, s24
    s_addc_u32 s57, s17, 0
    s_mov_b32 s58, 79392
    s_mov_b32 s59, 0x20000
    s_lshl_b32 s24, s84, 2
    s_lshr_b32 s24, 0xdb8530, s24
    s_mul_i32 s25, s85, 0
    s_add_u32 s24, s24, s25
    s_and_b32 s95, s24, 15
    s_mov_b32 s24, 0
    s_add_u32 s68, s18, s24
    s_addc_u32 s69, s19, 0
    s_mov_b32 s70, 256
    s_mov_b32 s71, 0x20000
    v_and_b32 v12, 7, v0
    v_lshlrev_b32 v17, 5, v12
    v_and_b32 v12, 1, v0
    v_lshlrev_b32 v12, 7, v12
    s_lshl_b32 s24, s83, 3
    s_add_u32 s24, s24, s84
    s_lshl_b32 s24, s24, 8
    v_add_u32 v19, s24, v12
    s_add_u32 s78, s78, 128
    s_cmp_eq_u32 s78, 1280
    s_cselect_b32 s78, 0, s78
    s_lshl_b32 s79, s78, 12
    s_add_u32 m0, s80, 24576
    s_add_u32 s24, s78, 0
    buffer_load_dwordx4 v2, s[28:31], s24 offen lds
    s_add_u32 m0, s80, 28672
    s_add_u32 s24, s78, 40960
    buffer_load_dwordx4 v2, s[28:31], s24 offen lds
    s_waitcnt vmcnt(12)
    s_barrier
    s_add_u32 m0, s80, 32768
    s_add_u32 s24, s78, 81920
    buffer_load_dwordx4 v2, s[28:31], s24 offen lds
    s_add_u32 m0, s80, 36864
    s_add_u32 s24, s78, 122880
    buffer_load_dwordx4 v2, s[28:31], s24 offen lds
    s_add_u32 m0, s80, 40960
    s_add_u32 s24, s78, 163840
    buffer_load_dwordx4 v2, s[28:31], s24 offen lds
    s_add_u32 m0, s80, 45056
    s_add_u32 s24, s78, 204800
    buffer_load_dwordx4 v2, s[28:31], s24 offen lds
    s_add_u32 m0, s80, 106496
    s_add_u32 s24, s79, 0
    buffer_load_dwordx4 v3, s[32:35], s24 offen lds
    s_add_u32 m0, s80, 110592
    s_add_u32 s24, s79, 131072
    buffer_load_dwordx4 v3, s[32:35], s24 offen lds
    s_add_u32 m0, s80, 73728
    s_add_u32 s24, s79, 262144
    buffer_load_dwordx4 v3, s[32:35], s24 offen lds
    s_add_u32 m0, s80, 77824
    s_add_u32 s24, s79, 393216
    buffer_load_dwordx4 v3, s[32:35], s24 offen lds
    s_waitcnt vmcnt(12)
    s_barrier
    s_add_u32 s78, s78, 128
    s_cmp_eq_u32 s78, 1280
    s_cselect_b32 s78, 0, s78
    s_lshl_b32 s79, s78, 12
    s_add_u32 m0, s80, 49152
    s_add_u32 s24, s78, 0
    buffer_load_dwordx4 v2, s[28:31], s24 offen lds
    s_add_u32 m0, s80, 53248
    s_add_u32 s24, s78, 40960
    buffer_load_dwordx4 v2, s[28:31], s24 offen lds
    s_waitcnt vmcnt(12)
    s_barrier
    s_cmp_eq_u32 s87, 1
    s_cbranch_scc1 L_var1
    s_cmp_eq_u32 s87, 2
    s_cbranch_scc1 L_var2
    s_branch L_var0
L_idle:
    s_branch L_done
.p2alignl 12, 0xbf810000
L_walk0:
L_pad0:
    s_branch L_pad4
L_var0:
    s_add_u32 m0, s80, 57344
    s_add_u32 s24, s78, 81920
    buffer_load_dwordx4 v2, s[28:31], s24 offen lds
    s_add_u32 m0, s80, 61440
    s_add_u32 s24, s78, 122880
    buffer_load_dwordx4 v2, s[28:31], s24 offen lds
    s_add_u32 m0, s80, 65536
    s_add_u32 s24, s78, 163840
    buffer_load_dwordx4 v2, s[28:31], s24 offen lds
    s_add_u32 m0, s80, 69632
    s_add_u32 s24, s78, 204800
    buffer_load_dwordx4 v2, s[28:31], s24 offen lds
    s_add_u32 m0, s80, 81920
    s_add_u32 s24, s79, 0
    buffer_load_dwordx4 v3, s[32:35], s24 offen lds
    s_add_u32 m0, s80, 86016
    s_add_u32 s24, s79, 131072
    buffer_load_dwordx4 v3, s[32:35], s24 offen lds
    s_add_u32 m0, s80, 114688
    s_mov_b32 s24, 0
    buffer_load_dwordx4 v5, s[36:39], s24 offen nt lds
    s_add_u32 m0, s80, 118784
    s_mov_b32 s24, 4096
    buffer_load_dwordx4 v5, s[36:39], s24 offen nt lds
    s_add_u32 m0, s80, 122880
    s_mov_b32 s24, 8192
    buffer_load_dwordx4 v5, s[36:39], s24 offen nt lds
    s_add_u32 m0, s80, 126976
    s_mov_b32 s24, 12288
    buffer_load_dwordx4 v5, s[36:39], s24 offen nt lds
    s_add_u32 m0, s80, 131072
    s_mov_b32 s24, 16384
    buffer_load_dwordx4 v5, s[36:39], s24 offen nt lds
    s_add_u32 m0, s80, 135168
    s_mov_b32 s24, 20480
    buffer_load_dwordx4 v5, s[36:39], s24 offen nt lds
    s_waitcnt vmcnt(16)
    s_barrier
    s_waitcnt vmcnt(14)
    s_barrier
    s_add_u32 m0, s80, 90112
    s_add_u32 s24, s79, 262144
    buffer_load_dwordx4 v3, s[32:35], s24 offen lds
    s_add_u32 m0, s80, 94208
    s_add_u32 s24, s79, 393216
    buffer_load_dwordx4 v3, s[32:35], s24 offen lds
    s_add_u32 s78, s78, 128
    s_cmp_eq_u32 s78, 1280
    s_cselect_b32 s78, 0, s78
    s_lshl_b32 s79, s78, 12
    s_add_u32 m0, s80, 0
    s_add_u32 s24, s78, 0
    buffer_load_dwordx4 v2, s[28:31], s24 offen lds
    s_add_u32 m0, s80, 4096
    s_add_u32 s24, s78, 40960
    buffer_load_dwordx4 v2, s[28:31], s24 offen lds
    s_add_u32 m0, s80, 8192
    s_add_u32 s24, s78, 81920
    buffer_load_dwordx4 v2, s[28:31], s24 offen lds
    s_add_u32 m0, s80, 12288
    s_add_u32 s24, s78, 122880
    buffer_load_dwordx4 v2, s[28:31], s24 offen lds
    s_add_u32 m0, s80, 16384
    s_add_u32 s24, s78, 163840
    buffer_load_dwordx4 v2, s[28:31], s24 offen lds
    s_add_u32 m0, s80, 20480
    s_add_u32 s24, s78, 204800
    buffer_load_dwordx4 v2, s[28:31], s24 offen lds
    s_waitcnt vmcnt(14)
    s_barrier
    s_lshl2_add_u32 s24, s86, s23
    s_cmpk_lg_u32 s24, 124
    s_cbranch_scc1 L_said0
    s_and_b32 s24, s2, 7
    s_lshl_b32 s24, s24, 5
    v_lshlrev_b32 v30, 8, v0
    v_mov_b32 v31, 1
    buffer_store_dword v31, v30, s[68:71], s24 offen sc1
L_said0:
    s_add_u32 m0, s80, 98304
    s_add_u32 s24, s79, 0
    buffer_load_dwordx4 v3, s[32:35], s24 offen lds
    s_add_u32 m0, s80, 102400
    s_add_u32 s24, s79, 131072
    buffer_load_dwordx4 v3, s[32:35], s24 offen lds
    s_add_u32 m0, s80, 106496
    s_add_u32 s24, s79, 262144
    buffer_load_dwordx4 v3, s[32:35], s24 offen lds
    s_add_u32 m0, s80, 110592
    s_add_u32 s24, s79, 393216
    buffer_load_dwordx4 v3, s[32:35], s24 offen lds
    s_add_u32 m0, s80, 139264
    s_mov_b32 s24, 786432
    buffer_load_dwordx4 v5, s[36:39], s24 offen nt lds
    s_add_u32 m0, s80, 143360
    s_mov_b32 s24, 790528
    buffer_load_dwordx4 v5, s[36:39], s24 offen nt lds
    s_add_u32 m0, s80, 147456
    s_mov_b32 s24, 794624
    buffer_load_dwordx4 v5, s[36:39], s24 offen nt lds
    s_add_u32 m0, s80, 151552
    s_mov_b32 s24, 798720
    buffer_load_dwordx4 v5, s[36:39], s24 offen nt lds
    s_add_u32 m0, s80, 155648
    s_mov_b32 s24, 802816
    buffer_load_dwordx4 v5, s[36:39], s24 offen nt lds
    s_add_u32 m0, s80, 159744
    s_mov_b32 s24, 806912
    buffer_load_dwordx4 v5, s[36:39], s24 offen nt lds
    s_waitcnt vmcnt(16)
    s_barrier
    s_add_u32 s78, s78, 128
    s_cmp_eq_u32 s78, 1280
    s_cselect_b32 s78, 0, s78
    s_lshl_b32 s79, s78, 12
    s_add_u32 m0, s80, 49152
    s_add_u32 s24, s78, 0
    buffer_load_dwordx4 v2, s[28:31], s24 offen lds
    s_add_u32 m0, s80, 53248
    s_add_u32 s24, s78, 40960
    buffer_load_dwordx4 v2, s[28:31], s24 offen lds
    s_add_u32 m0, s80, 57344
    s_add_u32 s24, s78, 81920
    buffer_load_dwordx4 v2, s[28:31], s24 offen lds
    s_add_u32 m0, s80, 61440
    s_add_u32 s24, s78, 122880
    buffer_load_dwordx4 v2, s[28:31], s24 offen lds
    s_add_u32 m0, s80, 65536
    s_add_u32 s24, s78, 163840
    buffer_load_dwordx4 v2, s[28:31], s24 offen lds
    s_add_u32 m0, s80, 69632
    s_add_u32 s24, s78, 204800
    buffer_load_dwordx4 v2, s[28:31], s24 offen lds
    s_waitcnt vmcnt(14)
    s_barrier
    s_add_u32 m0, s80, 73728
    s_add_u32 s24, s79, 0
    buffer_load_dwordx4 v3, s[32:35], s24 offen lds
    s_add_u32 m0, s80, 77824
    s_add_u32 s24, s79, 131072
    buffer_load_dwordx4 v3, s[32:35], s24 offen lds
    s_waitcnt vmcnt(14)
    s_barrier
    s_add_u32 m0, s80, 81920
    s_add_u32 s24, s79, 262144
    buffer_load_dwordx4 v3, s[32:35], s24 offen lds
    s_add_u32 m0, s80, 86016
    s_add_u32 s24, s79, 393216
    buffer_load_dwordx4 v3, s[32:35], s24 offen lds
    s_add_u32 s78, s78, 128
    s_cmp_eq_u32 s78, 1280
    s_cselect_b32 s78, 0, s78
    s_lshl_b32 s79, s78, 12
    s_add_u32 m0, s80, 24576
    s_add_u32 s24, s78, 0
    buffer_load_dwordx4 v2, s[28:31], s24 offen lds
    s_add_u32 m0, s80, 28672
    s_add_u32 s24, s78, 40960
    buffer_load_dwordx4 v2, s[28:31], s24 offen lds
    s_add_u32 m0, s80, 32768
    s_add_u32 s24, s78, 81920
    buffer_load_dwordx4 v2, s[28:31], s24 offen lds
    s_add_u32 m0, s80, 36864
    s_add_u32 s24, s78, 122880
    buffer_load_dwordx4 v2, s[28:31], s24 offen lds
    s_add_u32 m0, s80, 40960
    s_add_u32 s24, s78, 163840
    buffer_load_dwordx4 v2, s[28:31], s24 offen lds
    s_add_u32 m0, s80, 45056
    s_add_u32 s24, s78, 204800
    buffer_load_dwordx4 v2, s[28:31], s24 offen lds
    s_waitcnt vmcnt(8)
    s_barrier
    s_add_u32 m0, s80, 90112
    s_add_u32 s24, s79, 0
    buffer_load_dwordx4 v3, s[32:35], s24 offen lds
    s_add_u32 m0, s80, 94208
    s_add_u32 s24, s79, 131072
    buffer_load_dwordx4 v3, s[32:35], s24 offen lds
    s_add_u32 m0, s80, 0
    s_mov_b32 s24, 0
    buffer_load_dwordx4 v4, s[40:43], s24 offen nt lds
    s_add_u32 m0, s80, 4096
    s_mov_b32 s24, 4096
    buffer_load_dwordx4 v4, s[40:43], s24 offen nt lds
    s_add_u32 m0, s80, 8192
    s_mov_b32 s24, 8192
    buffer_load_dwordx4 v4, s[40:43], s24 offen nt lds
    s_add_u32 m0, s80, 12288
    s_mov_b32 s24, 12288
    buffer_load_dwordx4 v4, s[40:43], s24 offen nt lds
    s_add_u32 m0, s80, 16384
    s_mov_b32 s24, 16384
    buffer_load_dwordx4 v4, s[40:43], s24 offen nt lds
    s_add_u32 m0, s80, 20480
    s_mov_b32 s24, 20480
    buffer_load_dwordx4 v4, s[40:43], s24 offen nt lds
    s_waitcnt vmcnt(14)
    s_barrier
    s_add_u32 m0, s80, 98304
    s_add_u32 s24, s79, 262144
    buffer_load_dwordx4 v3, s[32:35], s24 offen lds
    s_add_u32 m0, s80, 102400
    s_add_u32 s24, s79, 393216
    buffer_load_dwordx4 v3, s[32:35], s24 offen lds
    s_add_u32 s78, s78, 128
    s_cmp_eq_u32 s78, 1280
    s_cselect_b32 s78, 0, s78
    s_lshl_b32 s79, s78, 12
    s_add_u32 m0, s80, 49152
    s_add_u32 s24, s78, 0
    buffer_load_dwordx4 v2, s[28:31], s24 offen nt lds
    s_add_u32 m0, s80, 53248
    s_add_u32 s24, s78, 40960
    buffer_load_dwordx4 v2, s[28:31], s24 offen nt lds
    s_add_u32 m0, s80, 57344
    s_add_u32 s24, s78, 81920
    buffer_load_dwordx4 v2, s[28:31], s24 offen nt lds
    s_add_u32 m0, s80, 61440
    s_add_u32 s24, s78, 122880
    buffer_load_dwordx4 v2, s[28:31], s24 offen nt lds
    s_waitcnt vmcnt(12)
    s_barrier
    s_add_u32 m0, s80, 65536
    s_add_u32 s24, s78, 163840
    buffer_load_dwordx4 v2, s[28:31], s24 offen nt lds
    s_add_u32 m0, s80, 69632
    s_add_u32 s24, s78, 204800
    buffer_load_dwordx4 v2, s[28:31], s24 offen nt lds
    s_add_u32 m0, s80, 106496
    s_add_u32 s24, s79, 0
    buffer_load_dwordx4 v3, s[32:35], s24 offen nt lds
    s_add_u32 m0, s80, 110592
    s_add_u32 s24, s79, 131072
    buffer_load_dwordx4 v3, s[32:35], s24 offen nt lds
    s_add_u32 m0, s80, 73728
    s_add_u32 s24, s79, 262144
    buffer_load_dwordx4 v3, s[32:35], s24 offen nt lds
    s_add_u32 m0, s80, 77824
    s_add_u32 s24, s79, 393216
    buffer_load_dwordx4 v3, s[32:35], s24 offen nt lds
    s_mov_b32 s24, 786432
    buffer_load_dword v29, v26, s[40:43], s24 offen
    s_waitcnt vmcnt(11)
    s_barrier
    s_add_u32 s78, s78, 128
    s_cmp_eq_u32 s78, 1280
    s_cselect_b32 s78, 0, s78
    s_lshl_b32 s79, s78, 12
    s_add_u32 m0, s80, 24576
    s_add_u32 s24, s78, 0
    buffer_load_dwordx4 v2, s[28:31], s24 offen nt lds
    s_add_u32 m0, s80, 28672
    s_add_u32 s24, s78, 40960
    buffer_load_dwordx4 v2, s[28:31], s24 offen nt lds
    s_add_u32 m0, s80, 32768
    s_add_u32 s24, s78, 81920
    buffer_load_dwordx4 v2, s[28:31], s24 offen nt lds
    s_add_u32 m0, s80, 36864
    s_add_u32 s24, s78, 122880
    buffer_load_dwordx4 v2, s[28:31], s24 offen nt lds
    s_add_u32 m0, s80, 40960
    s_add_u32 s24, s78, 163840
    buffer_load_dwordx4 v2, s[28:31], s24 offen nt lds
    s_add_u32 m0, s80, 45056
    s_add_u32 s24, s78, 204800
    buffer_load_dwordx4 v2, s[28:31], s24 offen nt lds
    s_waitcnt vmcnt(9)
    s_barrier
    s_add_u32 m0, s80, 81920
    s_add_u32 s24, s79, 0
    buffer_load_dwordx4 v3, s[32:35], s24 offen nt lds
    s_add_u32 m0, s80, 86016
    s_add_u32 s24, s79, 131072
    buffer_load_dwordx4 v3, s[32:35], s24 offen nt lds
    s_waitcnt vmcnt(9)
    s_barrier
    s_add_u32 m0, s80, 90112
    s_add_u32 s24, s79, 262144
    buffer_load_dwordx4 v3, s[32:35], s24 offen nt lds
    s_add_u32 m0, s80, 94208
    s_add_u32 s24, s79, 393216
    buffer_load_dwordx4 v3, s[32:35], s24 offen nt lds
    s_add_u32 s78, s78, 128
    s_cmp_eq_u32 s78, 1280
    s_cselect_b32 s78, 0, s78
    s_lshl_b32 s79, s78, 12
    s_add_u32 m0, s80, 49152
    s_add_u32 s24, s78, 0
    buffer_load_dwordx4 v2, s[28:31], s24 offen nt lds
    s_add_u32 m0, s80, 53248
    s_add_u32 s24, s78, 40960
    buffer_load_dwordx4 v2, s[28:31], s24 offen nt lds
    s_add_u32 m0, s80, 57344
    s_add_u32 s24, s78, 81920
    buffer_load_dwordx4 v2, s[28:31], s24 offen nt lds
    s_add_u32 m0, s80, 61440
    s_add_u32 s24, s78, 122880
    buffer_load_dwordx4 v2, s[28:31], s24 offen nt lds
    s_add_u32 m0, s80, 65536
    s_add_u32 s24, s78, 163840
    buffer_load_dwordx4 v2, s[28:31], s24 offen nt lds
    s_add_u32 m0, s80, 69632
    s_add_u32 s24, s78, 204800
    buffer_load_dwordx4 v2, s[28:31], s24 offen nt lds
    s_waitcnt vmcnt(8)
    s_barrier
    s_add_u32 m0, s80, 98304
    s_add_u32 s24, s79, 0
    buffer_load_dwordx4 v3, s[32:35], s24 offen nt lds
    s_add_u32 m0, s80, 102400
    s_add_u32 s24, s79, 131072
    buffer_load_dwordx4 v3, s[32:35], s24 offen nt lds
    s_add_u32 m0, s80, 106496
    s_add_u32 s24, s79, 262144
    buffer_load_dwordx4 v3, s[32:35], s24 offen nt lds
    s_add_u32 m0, s80, 110592
    s_add_u32 s24, s79, 393216
    buffer_load_dwordx4 v3, s[32:35], s24 offen nt lds
    s_waitcnt vmcnt(10)
    s_barrier
    s_add_u32 m0, s80, 24576
    s_mov_b32 s24, 786432
    buffer_load_dwordx4 v4, s[40:43], s24 offen nt lds
    s_add_u32 m0, s80, 28672
    s_mov_b32 s24, 790528
    buffer_load_dwordx4 v4, s[40:43], s24 offen nt lds
    s_add_u32 m0, s80, 32768
    s_mov_b32 s24, 794624
    buffer_load_dwordx4 v4, s[40:43], s24 offen nt lds
    s_add_u32 m0, s80, 36864
    s_mov_b32 s24, 798720
    buffer_load_dwordx4 v4, s[40:43], s24 offen nt lds
    s_add_u32 m0, s80, 40960
    s_mov_b32 s24, 802816
    buffer_load_dwordx4 v4, s[40:43], s24 offen nt lds
    buffer_load_dword v18, v17, s[68:71], 0 offen sc1
    s_add_u32 m0, s80, 45056
    s_mov_b32 s24, 806912
    buffer_load_dwordx4 v4, s[40:43], s24 offen nt lds
    s_add_u32 m0, s80, 81920
    s_add_u32 s24, s95, 0
    s_and_b32 s24, s24, 15
    s_mul_i32 s27, s24, 81920
    s_add_u32 s24, s27, 0
    buffer_load_dwordx4 v14, s[48:51], s24 offen lds
    s_add_u32 m0, s80, 86016
    s_add_u32 s24, s27, 20480
    buffer_load_dwordx4 v14, s[48:51], s24 offen lds
    s_waitcnt vmcnt(11)
    s_barrier
    s_add_u32 m0, s80, 90112
    s_add_u32 s24, s27, 40960
    buffer_load_dwordx4 v14, s[48:51], s24 offen lds
    s_add_u32 m0, s80, 94208
    s_add_u32 s24, s27, 61440
    buffer_load_dwordx4 v14, s[48:51], s24 offen lds
    s_waitcnt vmcnt(11)
    s_barrier
    s_add_u32 m0, s80, 49152
    s_add_u32 s24, s95, 1
    s_and_b32 s24, s24, 15
    s_mul_i32 s27, s24, 81920
    s_add_u32 s24, s27, 0
    buffer_load_dwordx4 v14, s[48:51], s24 offen lds
    s_add_u32 m0, s80, 53248
    s_add_u32 s24, s27, 20480
    buffer_load_dwordx4 v14, s[48:51], s24 offen lds
    s_add_u32 m0, s80, 57344
    s_add_u32 s24, s27, 40960
    buffer_load_dwordx4 v14, s[48:51], s24 offen lds
    s_add_u32 m0, s80, 61440
    s_add_u32 s24, s27, 61440
    buffer_load_dwordx4 v14, s[48:51], s24 offen lds
    s_barrier
    s_add_u32 m0, s80, 65536
    s_add_u32 s24, s95, 2
    s_and_b32 s24, s24, 15
    s_mul_i32 s27, s24, 81920
    s_add_u32 s24, s27, 0
    buffer_load_dwordx4 v14, s[48:51], s24 offen lds
    s_add_u32 m0, s80, 69632
    s_add_u32 s24, s27, 20480
    buffer_load_dwordx4 v14, s[48:51], s24 offen lds
    s_add_u32 m0, s80, 73728
    s_add_u32 s24, s27, 40960
    buffer_load_dwordx4 v14, s[48:51], s24 offen lds
    s_add_u32 m0, s80, 77824
    s_add_u32 s24, s27, 61440
    buffer_load_dwordx4 v14, s[48:51], s24 offen lds
    s_add_u32 m0, s80, 98304
    s_add_u32 s24, s95, 3
    s_and_b32 s24, s24, 15
    s_mul_i32 s27, s24, 81920
    s_add_u32 s24, s27, 0
    buffer_load_dwordx4 v14, s[48:51], s24 offen lds
    s_add_u32 m0, s80, 102400
    s_add_u32 s24, s27, 20480
    buffer_load_dwordx4 v14, s[48:51], s24 offen lds
    s_add_u32 m0, s80, 106496
    s_add_u32 s24, s27, 40960
    buffer_load_dwordx4 v14, s[48:51], s24 offen lds
    s_add_u32 m0, s80, 110592
    s_add_u32 s24, s27, 61440
    buffer_load_dwordx4 v14, s[48:51], s24 offen lds
    s_waitcnt vmcnt(16)
    v_cmp_ne_u32 vcc, 1, v18
    s_cbranch_vccz L_cnt0_ok
L_cnt0:
    buffer_load_dword v18, v17, s[68:71], 0 offen sc1
    s_add_u32 s98, s98, 0x2000
    s_cbranch_scc1 L_done
    s_waitcnt vmcnt(0)
    v_cmp_ne_u32 vcc, 1, v18
    s_cbranch_vccnz L_cnt0
L_cnt0_ok:
    s_barrier
    s_cmp_ge_u32 s86, 30
    s_cbranch_scc1 L_idle
    buffer_load_dword v29, v19, s[64:67], s91 offen sc1
    s_add_u32 m0, s80, 114688
    s_add_u32 s24, s95, 9
    s_and_b32 s24, s24, 15
    s_mul_i32 s27, s24, 81920
    s_add_u32 s24, s27, 0
    buffer_load_dwordx4 v14, s[48:51], s24 offen lds
    s_add_u32 m0, s80, 118784
    s_add_u32 s24, s27, 20480
    buffer_load_dwordx4 v14, s[48:51], s24 offen lds
    s_add_u32 m0, s80, 122880
    s_add_u32 s24, s27, 40960
    buffer_load_dwordx4 v14, s[48:51], s24 offen lds
    s_add_u32 m0, s80, 126976
    s_add_u32 s24, s27, 61440
    buffer_load_dwordx4 v14, s[48:51], s24 offen lds
    s_add_u32 m0, s80, 131072
    s_add_u32 s24, s95, 15
    s_and_b32 s24, s24, 15
    s_mul_i32 s27, s24, 81920
    s_add_u32 s24, s27, 0
    buffer_load_dwordx4 v14, s[48:51], s24 offen lds
    s_add_u32 m0, s80, 135168
    s_add_u32 s24, s27, 20480
    buffer_load_dwordx4 v14, s[48:51], s24 offen lds
    s_add_u32 m0, s80, 139264
    s_add_u32 s24, s27, 40960
    buffer_load_dwordx4 v14, s[48:51], s24 offen lds
    s_add_u32 m0, s80, 143360
    s_add_u32 s24, s27, 61440
    buffer_load_dwordx4 v14, s[48:51], s24 offen lds
    s_waitcnt vmcnt(0)
    s_barrier
    s_add_u32 m0, s80, 0
    s_add_u32 s24, s95, 4
    s_and_b32 s24, s24, 15
    s_mul_i32 s27, s24, 81920
    s_add_u32 s24, s27, 0
    buffer_load_dwordx4 v14, s[48:51], s24 offen lds
    s_add_u32 m0, s80, 4096
    s_add_u32 s24, s27, 20480
    buffer_load_dwordx4 v14, s[48:51], s24 offen lds
    s_add_u32 m0, s80, 8192
    s_add_u32 s24, s27, 40960
    buffer_load_dwordx4 v14, s[48:51], s24 offen lds
    s_add_u32 m0, s80, 12288
    s_add_u32 s24, s27, 61440
    buffer_load_dwordx4 v14, s[48:51], s24 offen lds
    s_add_u32 m0, s80, 16384
    s_add_u32 s24, s95, 5
    s_and_b32 s24, s24, 15
    s_mul_i32 s27, s24, 81920
    s_add_u32 s24, s27, 0
    buffer_load_dwordx4 v14, s[48:51], s24 offen lds
    s_add_u32 m0, s80, 20480
    s_add_u32 s24, s27, 20480
    buffer_load_dwordx4 v14, s[48:51], s24 offen lds
    s_add_u32 m0, s80, 24576
    s_add_u32 s24, s27, 40960
    buffer_load_dwordx4 v14, s[48:51], s24 offen lds
    s_add_u32 m0, s80, 28672
    s_add_u32 s24, s27, 61440
    buffer_load_dwordx4 v14, s[48:51], s24 offen lds
    s_add_u32 m0, s80, 32768
    s_add_u32 s24, s95, 6
    s_and_b32 s24, s24, 15
    s_mul_i32 s27, s24, 81920
    s_add_u32 s24, s27, 0
    buffer_load_dwordx4 v14, s[48:51], s24 offen lds
    s_add_u32 m0, s80, 36864
    s_add_u32 s24, s27, 20480
    buffer_load_dwordx4 v14, s[48:51], s24 offen lds
    s_add_u32 m0, s80, 40960
    s_add_u32 s24, s27, 40960
    buffer_load_dwordx4 v14, s[48:51], s24 offen lds
    s_add_u32 m0, s80, 45056
    s_add_u32 s24, s27, 61440
    buffer_load_dwordx4 v14, s[48:51], s24 offen lds
    s_branch L_common
.p2alignl 12, 0xbf810000
L_walk1:
L_pad1:
    s_branch L_pad5
L_var1:
    s_add_u32 m0, s80, 57344
    s_add_u32 s24, s78, 81920
    buffer_load_dwordx4 v2, s[28:31], s24 offen lds
    s_add_u32 m0, s80, 61440
    s_add_u32 s24, s78, 122880
    buffer_load_dwordx4 v2, s[28:31], s24 offen lds
    s_add_u32 m0, s80, 65536
    s_add_u32 s24, s78, 163840
    buffer_load_dwordx4 v2, s[28:31], s24 offen lds
    s_add_u32 m0, s80, 69632
    s_add_u32 s24, s78, 204800
    buffer_load_dwordx4 v2, s[28:31], s24 offen lds
    s_add_u32 m0, s80, 81920
    s_add_u32 s24, s79, 0
    buffer_load_dwordx4 v3, s[32:35], s24 offen lds
    s_add_u32 m0, s80, 86016
    s_add_u32 s24, s79, 131072
    buffer_load_dwordx4 v3, s[32:35], s24 offen lds
    s_add_u32 m0, s80, 90112
    s_add_u32 s24, s79, 262144
    buffer_load_dwordx4 v3, s[32:35], s24 offen lds
    s_add_u32 m0, s80, 94208
    s_add_u32 s24, s79, 393216
    buffer_load_dwordx4 v3, s[32:35], s24 offen lds
    s_waitcnt vmcnt(12)
    s_barrier
    s_add_u32 m0, s80, 114688
    s_mov_b32 s24, 0
    buffer_load_dwordx4 v5, s[36:39], s24 offen nt lds
    s_add_u32 m0, s80, 118784
    s_mov_b32 s24, 4096
    buffer_load_dwordx4 v5, s[36:39], s24 offen nt lds
    s_add_u32 m0, s80, 122880
    s_mov_b32 s24, 8192
    buffer_load_dwordx4 v5, s[36:39], s24 offen nt lds
    s_add_u32 m0, s80, 126976
    s_mov_b32 s24, 12288
    buffer_load_dwordx4 v5, s[36:39], s24 offen nt lds
    s_add_u32 m0, s80, 131072
    s_mov_b32 s24, 16384
    buffer_load_dwordx4 v5, s[36:39], s24 offen nt lds
    s_add_u32 m0, s80, 135168
    s_mov_b32 s24, 20480
    buffer_load_dwordx4 v5, s[36:39], s24 offen nt lds
    s_waitcnt vmcnt(16)
    s_barrier
    s_add_u32 s78, s78, 128
    s_cmp_eq_u32 s78, 1280
    s_cselect_b32 s78, 0, s78
    s_lshl_b32 s79, s78, 12
    s_add_u32 m0, s80, 0
    s_add_u32 s24, s78, 0
    buffer_load_dwordx4 v2, s[28:31], s24 offen lds
    s_add_u32 m0, s80, 4096
    s_add_u32 s24, s78, 40960
    buffer_load_dwordx4 v2, s[28:31], s24 offen lds
    s_add_u32 m0, s80, 8192
    s_add_u32 s24, s78, 81920
    buffer_load_dwordx4 v2, s[28:31], s24 offen lds
    s_add_u32 m0, s80, 12288
    s_add_u32 s24, s78, 122880
    buffer_load_dwordx4 v2, s[28:31], s24 offen lds
    s_add_u32 m0, s80, 16384
    s_add_u32 s24, s78, 163840
    buffer_load_dwordx4 v2, s[28:31], s24 offen lds
    s_add_u32 m0, s80, 20480
    s_add_u32 s24, s78, 204800
    buffer_load_dwordx4 v2, s[28:31], s24 offen lds
    s_waitcnt vmcnt(14)
    s_barrier
    s_lshl2_add_u32 s24, s86, s23
    s_cmpk_lg_u32 s24, 124
    s_cbranch_scc1 L_said1
    s_and_b32 s24, s2, 7
    s_lshl_b32 s24, s24, 5
    v_lshlrev_b32 v30, 8, v0
    v_mov_b32 v31, 1
    buffer_store_dword v31, v30, s[68:71], s24 offen sc1
L_said1:
    s_add_u32 m0, s80, 98304
    s_add_u32 s24, s79, 0
    buffer_load_dwordx4 v3, s[32:35], s24 offen lds
    s_add_u32 m0, s80, 102400
    s_add_u32 s24, s79, 131072
    buffer_load_dwordx4 v3, s[32:35], s24 offen lds
    s_waitcnt vmcnt(14)
    s_barrier
    s_add_u32 m0, s80, 106496
    s_add_u32 s24, s79, 262144
    buffer_load_dwordx4 v3, s[32:35], s24 offen lds
    s_add_u32 m0, s80, 110592
    s_add_u32 s24, s79, 393216
    buffer_load_dwordx4 v3, s[32:35], s24 offen lds
    s_add_u32 s78, s78, 128
    s_cmp_eq_u32 s78, 1280
    s_cselect_b32 s78, 0, s78
    s_lshl_b32 s79, s78, 12
    s_add_u32 m0, s80, 49152
    s_add_u32 s24, s78, 0
    buffer_load_dwordx4 v2, s[28:31], s24 offen lds
    s_add_u32 m0, s80, 53248
    s_add_u32 s24, s78, 40960
    buffer_load_dwordx4 v2, s[28:31], s24 offen lds
    s_add_u32 m0, s80, 57344
    s_add_u32 s24, s78, 81920
    buffer_load_dwordx4 v2, s[28:31], s24 offen lds
    s_add_u32 m0, s80, 61440
    s_add_u32 s24, s78, 122880
    buffer_load_dwordx4 v2, s[28:31], s24 offen lds
    s_add_u32 m0, s80, 65536
    s_add_u32 s24, s78, 163840
    buffer_load_dwordx4 v2, s[28:31], s24 offen lds
    s_add_u32 m0, s80, 69632
    s_add_u32 s24, s78, 204800
    buffer_load_dwordx4 v2, s[28:31], s24 offen lds
    s_waitcnt vmcnt(8)
    s_barrier
    s_add_u32 m0, s80, 73728
    s_add_u32 s24, s79, 0
    buffer_load_dwordx4 v3, s[32:35], s24 offen lds
    s_add_u32 m0, s80, 77824
    s_add_u32 s24, s79, 131072
    buffer_load_dwordx4 v3, s[32:35], s24 offen lds
    s_add_u32 m0, s80, 139264
    s_mov_b32 s24, 786432
    buffer_load_dwordx4 v5, s[36:39], s24 offen nt lds
    s_add_u32 m0, s80, 143360
    s_mov_b32 s24, 790528
    buffer_load_dwordx4 v5, s[36:39], s24 offen nt lds
    s_add_u32 m0, s80, 147456
    s_mov_b32 s24, 794624
    buffer_load_dwordx4 v5, s[36:39], s24 offen nt lds
    s_add_u32 m0, s80, 151552
    s_mov_b32 s24, 798720
    buffer_load_dwordx4 v5, s[36:39], s24 offen nt lds
    s_add_u32 m0, s80, 155648
    s_mov_b32 s24, 802816
    buffer_load_dwordx4 v5, s[36:39], s24 offen nt lds
    s_add_u32 m0, s80, 159744
    s_mov_b32 s24, 806912
    buffer_load_dwordx4 v5, s[36:39], s24 offen nt lds
    s_waitcnt vmcnt(14)
    s_barrier
    s_add_u32 m0, s80, 81920
    s_add_u32 s24, s79, 262144
    buffer_load_dwordx4 v3, s[32:35], s24 offen lds
    s_add_u32 m0, s80, 86016
    s_add_u32 s24, s79, 393216
    buffer_load_dwordx4 v3, s[32:35], s24 offen lds
    s_add_u32 s78, s78, 128
    s_cmp_eq_u32 s78, 1280
    s_cselect_b32 s78, 0, s78
    s_lshl_b32 s79, s78, 12
    s_add_u32 m0, s80, 24576
    s_add_u32 s24, s78, 0
    buffer_load_dwordx4 v2, s[28:31], s24 offen lds
    s_add_u32 m0, s80, 28672
    s_add_u32 s24, s78, 40960
    buffer_load_dwordx4 v2, s[28:31], s24 offen lds
    s_add_u32 m0, s80, 32768
    s_add_u32 s24, s78, 81920
    buffer_load_dwordx4 v2, s[28:31], s24 offen lds
    s_add_u32 m0, s80, 36864
    s_add_u32 s24, s78, 122880
    buffer_load_dwordx4 v2, s[28:31], s24 offen lds
    s_waitcnt vmcnt(12)
    s_barrier
    s_add_u32 m0, s80, 40960
    s_add_u32 s24, s78, 163840
    buffer_load_dwordx4 v2, s[28:31], s24 offen lds
    s_add_u32 m0, s80, 45056
    s_add_u32 s24, s78, 204800
    buffer_load_dwordx4 v2, s[28:31], s24 offen lds
    s_add_u32 m0, s80, 90112
    s_add_u32 s24, s79, 0
    buffer_load_dwordx4 v3, s[32:35], s24 offen lds
    s_add_u32 m0, s80, 94208
    s_add_u32 s24, s79, 131072
    buffer_load_dwordx4 v3, s[32:35], s24 offen lds
    s_add_u32 m0, s80, 98304
    s_add_u32 s24, s79, 262144
    buffer_load_dwordx4 v3, s[32:35], s24 offen lds
    s_add_u32 m0, s80, 102400
    s_add_u32 s24, s79, 393216
    buffer_load_dwordx4 v3, s[32:35], s24 offen lds
    s_add_u32 m0, s80, 0
    s_mov_b32 s24, 0
    buffer_load_dwordx4 v4, s[40:43], s24 offen nt lds
    s_add_u32 m0, s80, 4096
    s_mov_b32 s24, 4096
    buffer_load_dwordx4 v4, s[40:43], s24 offen nt lds
    s_add_u32 m0, s80, 8192
    s_mov_b32 s24, 8192
    buffer_load_dwordx4 v4, s[40:43], s24 offen nt lds
    s_add_u32 m0, s80, 12288
    s_mov_b32 s24, 12288
    buffer_load_dwordx4 v4, s[40:43], s24 offen nt lds
    s_add_u32 m0, s80, 16384
    s_mov_b32 s24, 16384
    buffer_load_dwordx4 v4, s[40:43], s24 offen nt lds
    s_add_u32 m0, s80, 20480
    s_mov_b32 s24, 20480
    buffer_load_dwordx4 v4, s[40:43], s24 offen nt lds
    s_waitcnt vmcnt(16)
    s_barrier
    s_add_u32 s78, s78, 128
    s_cmp_eq_u32 s78, 1280
    s_cselect_b32 s78, 0, s78
    s_lshl_b32 s79, s78, 12
    s_add_u32 m0, s80, 49152
    s_add_u32 s24, s78, 0
    buffer_load_dwordx4 v2, s[28:31], s24 offen nt lds
    s_add_u32 m0, s80, 53248
    s_add_u32 s24, s78, 40960
    buffer_load_dwordx4 v2, s[28:31], s24 offen nt lds
    s_add_u32 m0, s80, 57344
    s_add_u32 s24, s78, 81920
    buffer_load_dwordx4 v2, s[28:31], s24 offen nt lds
    s_add_u32 m0, s80, 61440
    s_add_u32 s24, s78, 122880
    buffer_load_dwordx4 v2, s[28:31], s24 offen nt lds
    s_add_u32 m0, s80, 65536
    s_add_u32 s24, s78, 163840
    buffer_load_dwordx4 v2, s[28:31], s24 offen nt lds
    s_add_u32 m0, s80, 69632
    s_add_u32 s24, s78, 204800
    buffer_load_dwordx4 v2, s[28:31], s24 offen nt lds
    s_waitcnt vmcnt(14)
    s_barrier
    s_add_u32 m0, s80, 106496
    s_add_u32 s24, s79, 0
    buffer_load_dwordx4 v3, s[32:35], s24 offen nt lds
    s_add_u32 m0, s80, 110592
    s_add_u32 s24, s79, 131072
    buffer_load_dwordx4 v3, s[32:35], s24 offen nt lds
    s_waitcnt vmcnt(14)
    s_barrier
    s_add_u32 m0, s80, 73728
    s_add_u32 s24, s79, 262144
    buffer_load_dwordx4 v3, s[32:35], s24 offen nt lds
    s_add_u32 m0, s80, 77824
    s_add_u32 s24, s79, 393216
    buffer_load_dwordx4 v3, s[32:35], s24 offen nt lds
    s_add_u32 s78, s78, 128
    s_cmp_eq_u32 s78, 1280
    s_cselect_b32 s78, 0, s78
    s_lshl_b32 s79, s78, 12
    s_add_u32 m0, s80, 24576
    s_add_u32 s24, s78, 0
    buffer_load_dwordx4 v2, s[28:31], s24 offen nt lds
    s_add_u32 m0, s80, 28672
    s_add_u32 s24, s78, 40960
    buffer_load_dwordx4 v2, s[28:31], s24 offen nt lds
    s_add_u32 m0, s80, 32768
    s_add_u32 s24, s78, 81920
    buffer_load_dwordx4 v2, s[28:31], s24 offen nt lds
    s_add_u32 m0, s80, 36864
    s_add_u32 s24, s78, 122880
    buffer_load_dwordx4 v2, s[28:31], s24 offen nt lds
    s_add_u32 m0, s80, 40960
    s_add_u32 s24, s78, 163840
    buffer_load_dwordx4 v2, s[28:31], s24 offen nt lds
    s_add_u32 m0, s80, 45056
    s_add_u32 s24, s78, 204800
    buffer_load_dwordx4 v2, s[28:31], s24 offen nt lds
    s_waitcnt vmcnt(8)
    s_barrier
    s_add_u32 m0, s80, 81920
    s_add_u32 s24, s79, 0
    buffer_load_dwordx4 v3, s[32:35], s24 offen nt lds
    s_add_u32 m0, s80, 86016
    s_add_u32 s24, s79, 131072
    buffer_load_dwordx4 v3, s[32:35], s24 offen nt lds
    s_mov_b32 s24, 786432
    buffer_load_dword v29, v26, s[40:43], s24 offen
    s_waitcnt vmcnt(9)
    s_barrier
    s_add_u32 m0, s80, 90112
    s_add_u32 s24, s79, 262144
    buffer_load_dwordx4 v3, s[32:35], s24 offen nt lds
    s_add_u32 m0, s80, 94208
    s_add_u32 s24, s79, 393216
    buffer_load_dwordx4 v3, s[32:35], s24 offen nt lds
    s_add_u32 s78, s78, 128
    s_cmp_eq_u32 s78, 1280
    s_cselect_b32 s78, 0, s78
    s_lshl_b32 s79, s78, 12
    s_add_u32 m0, s80, 49152
    s_add_u32 s24, s78, 0
    buffer_load_dwordx4 v2, s[28:31], s24 offen nt lds
    s_add_u32 m0, s80, 53248
    s_add_u32 s24, s78, 40960
    buffer_load_dwordx4 v2, s[28:31], s24 offen nt lds
    s_add_u32 m0, s80, 57344
    s_add_u32 s24, s78, 81920
    buffer_load_dwordx4 v2, s[28:31], s24 offen nt lds
    s_add_u32 m0, s80, 61440
    s_add_u32 s24, s78, 122880
    buffer_load_dwordx4 v2, s[28:31], s24 offen nt lds
    s_waitcnt vmcnt(7)
    s_barrier
    s_add_u32 m0, s80, 65536
    s_add_u32 s24, s78, 163840
    buffer_load_dwordx4 v2, s[28:31], s24 offen nt lds
    s_add_u32 m0, s80, 69632
    s_add_u32 s24, s78, 204800
    buffer_load_dwordx4 v2, s[28:31], s24 offen nt lds
    s_add_u32 m0, s80, 98304
    s_add_u32 s24, s79, 0
    buffer_load_dwordx4 v3, s[32:35], s24 offen nt lds
    s_add_u32 m0, s80, 102400
    s_add_u32 s24, s79, 131072
    buffer_load_dwordx4 v3, s[32:35], s24 offen nt lds
    s_add_u32 m0, s80, 106496
    s_add_u32 s24, s79, 262144
    buffer_load_dwordx4 v3, s[32:35], s24 offen nt lds
    s_add_u32 m0, s80, 110592
    s_add_u32 s24, s79, 393216
    buffer_load_dwordx4 v3, s[32:35], s24 offen nt lds
    s_waitcnt vmcnt(10)
    s_barrier
    s_add_u32 m0, s80, 24576
    s_mov_b32 s24, 786432
    buffer_load_dwordx4 v4, s[40:43], s24 offen nt lds
    s_add_u32 m0, s80, 28672
    s_mov_b32 s24, 790528
    buffer_load_dwordx4 v4, s[40:43], s24 offen nt lds
    s_add_u32 m0, s80, 32768
    s_mov_b32 s24, 794624
    buffer_load_dwordx4 v4, s[40:43], s24 offen nt lds
    s_add_u32 m0, s80, 36864
    s_mov_b32 s24, 798720
    buffer_load_dwordx4 v4, s[40:43], s24 offen nt lds
    s_add_u32 m0, s80, 40960
    s_mov_b32 s24, 802816
    buffer_load_dwordx4 v4, s[40:43], s24 offen nt lds
    buffer_load_dword v18, v17, s[68:71], 0 offen sc1
    s_add_u32 m0, s80, 45056
    s_mov_b32 s24, 806912
    buffer_load_dwordx4 v4, s[40:43], s24 offen nt lds
    s_add_u32 m0, s80, 81920
    s_add_u32 s24, s95, 0
    s_and_b32 s24, s24, 15
    s_mul_i32 s27, s24, 81920
    s_add_u32 s24, s27, 0
    buffer_load_dwordx4 v14, s[48:51], s24 offen lds
    s_add_u32 m0, s80, 86016
    s_add_u32 s24, s27, 20480
    buffer_load_dwordx4 v14, s[48:51], s24 offen lds
    s_waitcnt vmcnt(11)
    s_barrier
    s_add_u32 m0, s80, 90112
    s_add_u32 s24, s27, 40960
    buffer_load_dwordx4 v14, s[48:51], s24 offen lds
    s_add_u32 m0, s80, 94208
    s_add_u32 s24, s27, 61440
    buffer_load_dwordx4 v14, s[48:51], s24 offen lds
    s_waitcnt vmcnt(11)
    s_barrier
    s_add_u32 m0, s80, 49152
    s_add_u32 s24, s95, 1
    s_and_b32 s24, s24, 15
    s_mul_i32 s27, s24, 81920
    s_add_u32 s24, s27, 0
    buffer_load_dwordx4 v14, s[48:51], s24 offen lds
    s_add_u32 m0, s80, 53248
    s_add_u32 s24, s27, 20480
    buffer_load_dwordx4 v14, s[48:51], s24 offen lds
    s_add_u32 m0, s80, 57344
    s_add_u32 s24, s27, 40960
    buffer_load_dwordx4 v14, s[48:51], s24 offen lds
    s_add_u32 m0, s80, 61440
    s_add_u32 s24, s27, 61440
    buffer_load_dwordx4 v14, s[48:51], s24 offen lds
    s_barrier
    s_add_u32 m0, s80, 65536
    s_add_u32 s24, s95, 2
    s_and_b32 s24, s24, 15
    s_mul_i32 s27, s24, 81920
    s_add_u32 s24, s27, 0
    buffer_load_dwordx4 v14, s[48:51], s24 offen lds
    s_add_u32 m0, s80, 69632
    s_add_u32 s24, s27, 20480
    buffer_load_dwordx4 v14, s[48:51], s24 offen lds
    s_add_u32 m0, s80, 73728
    s_add_u32 s24, s27, 40960
    buffer_load_dwordx4 v14, s[48:51], s24 offen lds
    s_add_u32 m0, s80, 77824
    s_add_u32 s24, s27, 61440
    buffer_load_dwordx4 v14, s[48:51], s24 offen lds
    s_add_u32 m0, s80, 98304
    s_add_u32 s24, s95, 3
    s_and_b32 s24, s24, 15
    s_mul_i32 s27, s24, 81920
    s_add_u32 s24, s27, 0
    buffer_load_dwordx4 v14, s[48:51], s24 offen lds
    s_add_u32 m0, s80, 102400
    s_add_u32 s24, s27, 20480
    buffer_load_dwordx4 v14, s[48:51], s24 offen lds
    s_add_u32 m0, s80, 106496
    s_add_u32 s24, s27, 40960
    buffer_load_dwordx4 v14, s[48:51], s24 offen lds
    s_add_u32 m0, s80, 110592
    s_add_u32 s24, s27, 61440
    buffer_load_dwordx4 v14, s[48:51], s24 offen lds
    s_waitcnt vmcnt(16)
    v_cmp_ne_u32 vcc, 1, v18
    s_cbranch_vccz L_cnt1_ok
L_cnt1:
    buffer_load_dword v18, v17, s[68:71], 0 offen sc1
    s_add_u32 s98, s98, 0x2000
    s_cbranch_scc1 L_done
    s_waitcnt vmcnt(0)
    v_cmp_ne_u32 vcc, 1, v18
    s_cbranch_vccnz L_cnt1
L_cnt1_ok:
    s_barrier
    s_cmp_ge_u32 s86, 30
    s_cbranch_scc1 L_idle
    buffer_load_dword v29, v19, s[64:67], s91 offen sc1
    s_add_u32 m0, s80, 114688
    s_add_u32 s24, s95, 9
    s_and_b32 s24, s24, 15
    s_mul_i32 s27, s24, 81920
    s_add_u32 s24, s27, 0
    buffer_load_dwordx4 v14, s[48:51], s24 offen lds
    s_add_u32 m0, s80, 118784
    s_add_u32 s24, s27, 20480
    buffer_load_dwordx4 v14, s[48:51], s24 offen lds
    s_add_u32 m0, s80, 122880
    s_add_u32 s24, s27, 40960
    buffer_load_dwordx4 v14, s[48:51], s24 offen lds
    s_add_u32 m0, s80, 126976
    s_add_u32 s24, s27, 61440
    buffer_load_dwordx4 v14, s[48:51], s24 offen lds
    s_add_u32 m0, s80, 131072
    s_add_u32 s24, s95, 15
    s_and_b32 s24, s24, 15
    s_mul_i32 s27, s24, 81920
    s_add_u32 s24, s27, 0
    buffer_load_dwordx4 v14, s[48:51], s24 offen lds
    s_add_u32 m0, s80, 135168
    s_add_u32 s24, s27, 20480
    buffer_load_dwordx4 v14, s[48:51], s24 offen lds
    s_add_u32 m0, s80, 139264
    s_add_u32 s24, s27, 40960
    buffer_load_dwordx4 v14, s[48:51], s24 offen lds
    s_add_u32 m0, s80, 143360
    s_add_u32 s24, s27, 61440
    buffer_load_dwordx4 v14, s[48:51], s24 offen lds
    s_waitcnt vmcnt(0)
    s_barrier
    s_add_u32 m0, s80, 0
    s_add_u32 s24, s95, 4
    s_and_b32 s24, s24, 15
    s_mul_i32 s27, s24, 81920
    s_add_u32 s24, s27, 0
    buffer_load_dwordx4 v14, s[48:51], s24 offen lds
    s_add_u32 m0, s80, 4096
    s_add_u32 s24, s27, 20480
    buffer_load_dwordx4 v14, s[48:51], s24 offen lds
    s_add_u32 m0, s80, 8192
    s_add_u32 s24, s27, 40960
    buffer_load_dwordx4 v14, s[48:51], s24 offen lds
    s_add_u32 m0, s80, 12288
    s_add_u32 s24, s27, 61440
    buffer_load_dwordx4 v14, s[48:51], s24 offen lds
    s_add_u32 m0, s80, 16384
    s_add_u32 s24, s95, 5
    s_and_b32 s24, s24, 15
    s_mul_i32 s27, s24, 81920
    s_add_u32 s24, s27, 0
    buffer_load_dwordx4 v14, s[48:51], s24 offen lds
    s_add_u32 m0, s80, 20480
    s_add_u32 s24, s27, 20480
    buffer_load_dwordx4 v14, s[48:51], s24 offen lds
    s_add_u32 m0, s80, 24576
    s_add_u32 s24, s27, 40960
    buffer_load_dwordx4 v14, s[48:51], s24 offen lds
    s_add_u32 m0, s80, 28672
    s_add_u32 s24, s27, 61440
    buffer_load_dwordx4 v14, s[48:51], s24 offen lds
    s_add_u32 m0, s80, 32768
    s_add_u32 s24, s95, 6
    s_and_b32 s24, s24, 15
    s_mul_i32 s27, s24, 81920
    s_add_u32 s24, s27, 0
    buffer_load_dwordx4 v14, s[48:51], s24 offen lds
    s_add_u32 m0, s80, 36864
    s_add_u32 s24, s27, 20480
    buffer_load_dwordx4 v14, s[48:51], s24 offen lds
    s_add_u32 m0, s80, 40960
    s_add_u32 s24, s27, 40960
    buffer_load_dwordx4 v14, s[48:51], s24 offen lds
    s_add_u32 m0, s80, 45056
    s_add_u32 s24, s27, 61440
    buffer_load_dwordx4 v14, s[48:51], s24 offen lds
    s_branch L_common
.p2alignl 12, 0xbf810000
L_walk2:
L_pad2:
    s_branch L_pad6
L_var2:
    s_add_u32 m0, s80, 57344
    s_add_u32 s24, s78, 81920
    buffer_load_dwordx4 v2, s[28:31], s24 offen lds
    s_add_u32 m0, s80, 61440
    s_add_u32 s24, s78, 122880
    buffer_load_dwordx4 v2, s[28:31], s24 offen lds
    s_add_u32 m0, s80, 65536
    s_add_u32 s24, s78, 163840
    buffer_load_dwordx4 v2, s[28:31], s24 offen lds
    s_add_u32 m0, s80, 69632
    s_add_u32 s24, s78, 204800
    buffer_load_dwordx4 v2, s[28:31], s24 offen lds
    s_add_u32 m0, s80, 81920
    s_add_u32 s24, s79, 0
    buffer_load_dwordx4 v3, s[32:35], s24 offen lds
    s_add_u32 m0, s80, 86016
    s_add_u32 s24, s79, 131072
    buffer_load_dwordx4 v3, s[32:35], s24 offen lds
    s_add_u32 m0, s80, 90112
    s_add_u32 s24, s79, 262144
    buffer_load_dwordx4 v3, s[32:35], s24 offen lds
    s_add_u32 m0, s80, 94208
    s_add_u32 s24, s79, 393216
    buffer_load_dwordx4 v3, s[32:35], s24 offen lds
    s_waitcnt vmcnt(12)
    s_barrier
    s_add_u32 s78, s78, 128
    s_cmp_eq_u32 s78, 1280
    s_cselect_b32 s78, 0, s78
    s_lshl_b32 s79, s78, 12
    s_add_u32 m0, s80, 0
    s_add_u32 s24, s78, 0
    buffer_load_dwordx4 v2, s[28:31], s24 offen lds
    s_add_u32 m0, s80, 4096
    s_add_u32 s24, s78, 40960
    buffer_load_dwordx4 v2, s[28:31], s24 offen lds
    s_waitcnt vmcnt(12)
    s_barrier
    s_add_u32 m0, s80, 8192
    s_add_u32 s24, s78, 81920
    buffer_load_dwordx4 v2, s[28:31], s24 offen lds
    s_add_u32 m0, s80, 12288
    s_add_u32 s24, s78, 122880
    buffer_load_dwordx4 v2, s[28:31], s24 offen lds
    s_add_u32 m0, s80, 16384
    s_add_u32 s24, s78, 163840
    buffer_load_dwordx4 v2, s[28:31], s24 offen lds
    s_add_u32 m0, s80, 20480
    s_add_u32 s24, s78, 204800
    buffer_load_dwordx4 v2, s[28:31], s24 offen lds
    s_add_u32 m0, s80, 98304
    s_add_u32 s24, s79, 0
    buffer_load_dwordx4 v3, s[32:35], s24 offen lds
    s_add_u32 m0, s80, 102400
    s_add_u32 s24, s79, 131072
    buffer_load_dwordx4 v3, s[32:35], s24 offen lds
    s_add_u32 m0, s80, 114688
    s_mov_b32 s24, 0
    buffer_load_dwordx4 v5, s[36:39], s24 offen nt lds
    s_add_u32 m0, s80, 118784
    s_mov_b32 s24, 4096
    buffer_load_dwordx4 v5, s[36:39], s24 offen nt lds
    s_add_u32 m0, s80, 122880
    s_mov_b32 s24, 8192
    buffer_load_dwordx4 v5, s[36:39], s24 offen nt lds
    s_add_u32 m0, s80, 126976
    s_mov_b32 s24, 12288
    buffer_load_dwordx4 v5, s[36:39], s24 offen nt lds
    s_add_u32 m0, s80, 131072
    s_mov_b32 s24, 16384
    buffer_load_dwordx4 v5, s[36:39], s24 offen nt lds
    s_add_u32 m0, s80, 135168
    s_mov_b32 s24, 20480
    buffer_load_dwordx4 v5, s[36:39], s24 offen nt lds
    s_waitcnt vmcnt(16)
    s_barrier
    s_lshl2_add_u32 s24, s86, s23
    s_cmpk_lg_u32 s24, 124
    s_cbranch_scc1 L_said2
    s_and_b32 s24, s2, 7
    s_lshl_b32 s24, s24, 5
    v_lshlrev_b32 v30, 8, v0
    v_mov_b32 v31, 1
    buffer_store_dword v31, v30, s[68:71], s24 offen sc1
L_said2:
    s_waitcnt vmcnt(14)
    s_barrier
    s_add_u32 m0, s80, 106496
    s_add_u32 s24, s79, 262144
    buffer_load_dwordx4 v3, s[32:35], s24 offen lds
    s_add_u32 m0, s80, 110592
    s_add_u32 s24, s79, 393216
    buffer_load_dwordx4 v3, s[32:35], s24 offen lds
    s_add_u32 s78, s78, 128
    s_cmp_eq_u32 s78, 1280
    s_cselect_b32 s78, 0, s78
    s_lshl_b32 s79, s78, 12
    s_add_u32 m0, s80, 49152
    s_add_u32 s24, s78, 0
    buffer_load_dwordx4 v2, s[28:31], s24 offen lds
    s_add_u32 m0, s80, 53248
    s_add_u32 s24, s78, 40960
    buffer_load_dwordx4 v2, s[28:31], s24 offen lds
    s_add_u32 m0, s80, 57344
    s_add_u32 s24, s78, 81920
    buffer_load_dwordx4 v2, s[28:31], s24 offen lds
    s_add_u32 m0, s80, 61440
    s_add_u32 s24, s78, 122880
    buffer_load_dwordx4 v2, s[28:31], s24 offen lds
    s_add_u32 m0, s80, 65536
    s_add_u32 s24, s78, 163840
    buffer_load_dwordx4 v2, s[28:31], s24 offen lds
    s_add_u32 m0, s80, 69632
    s_add_u32 s24, s78, 204800
    buffer_load_dwordx4 v2, s[28:31], s24 offen lds
    s_waitcnt vmcnt(14)
    s_barrier
    s_add_u32 m0, s80, 73728
    s_add_u32 s24, s79, 0
    buffer_load_dwordx4 v3, s[32:35], s24 offen lds
    s_add_u32 m0, s80, 77824
    s_add_u32 s24, s79, 131072
    buffer_load_dwordx4 v3, s[32:35], s24 offen lds
    s_add_u32 m0, s80, 81920
    s_add_u32 s24, s79, 262144
    buffer_load_dwordx4 v3, s[32:35], s24 offen lds
    s_add_u32 m0, s80, 86016
    s_add_u32 s24, s79, 393216
    buffer_load_dwordx4 v3, s[32:35], s24 offen lds
    s_add_u32 m0, s80, 139264
    s_mov_b32 s24, 786432
    buffer_load_dwordx4 v5, s[36:39], s24 offen nt lds
    s_add_u32 m0, s80, 143360
    s_mov_b32 s24, 790528
    buffer_load_dwordx4 v5, s[36:39], s24 offen nt lds
    s_add_u32 m0, s80, 147456
    s_mov_b32 s24, 794624
    buffer_load_dwordx4 v5, s[36:39], s24 offen nt lds
    s_add_u32 m0, s80, 151552
    s_mov_b32 s24, 798720
    buffer_load_dwordx4 v5, s[36:39], s24 offen nt lds
    s_add_u32 m0, s80, 155648
    s_mov_b32 s24, 802816
    buffer_load_dwordx4 v5, s[36:39], s24 offen nt lds
    s_add_u32 m0, s80, 159744
    s_mov_b32 s24, 806912
    buffer_load_dwordx4 v5, s[36:39], s24 offen nt lds
    s_waitcnt vmcnt(16)
    s_barrier
    s_add_u32 s78, s78, 128
    s_cmp_eq_u32 s78, 1280
    s_cselect_b32 s78, 0, s78
    s_lshl_b32 s79, s78, 12
    s_add_u32 m0, s80, 24576
    s_add_u32 s24, s78, 0
    buffer_load_dwordx4 v2, s[28:31], s24 offen lds
    s_add_u32 m0, s80, 28672
    s_add_u32 s24, s78, 40960
    buffer_load_dwordx4 v2, s[28:31], s24 offen lds
    s_add_u32 m0, s80, 32768
    s_add_u32 s24, s78, 81920
    buffer_load_dwordx4 v2, s[28:31], s24 offen lds
    s_add_u32 m0, s80, 36864
    s_add_u32 s24, s78, 122880
    buffer_load_dwordx4 v2, s[28:31], s24 offen lds
    s_add_u32 m0, s80, 40960
    s_add_u32 s24, s78, 163840
    buffer_load_dwordx4 v2, s[28:31], s24 offen lds
    s_add_u32 m0, s80, 45056
    s_add_u32 s24, s78, 204800
    buffer_load_dwordx4 v2, s[28:31], s24 offen lds
    s_waitcnt vmcnt(14)
    s_barrier
    s_add_u32 m0, s80, 90112
    s_add_u32 s24, s79, 0
    buffer_load_dwordx4 v3, s[32:35], s24 offen lds
    s_add_u32 m0, s80, 94208
    s_add_u32 s24, s79, 131072
    buffer_load_dwordx4 v3, s[32:35], s24 offen lds
    s_waitcnt vmcnt(14)
    s_barrier
    s_add_u32 m0, s80, 98304
    s_add_u32 s24, s79, 262144
    buffer_load_dwordx4 v3, s[32:35], s24 offen lds
    s_add_u32 m0, s80, 102400
    s_add_u32 s24, s79, 393216
    buffer_load_dwordx4 v3, s[32:35], s24 offen lds
    s_add_u32 s78, s78, 128
    s_cmp_eq_u32 s78, 1280
    s_cselect_b32 s78, 0, s78
    s_lshl_b32 s79, s78, 12
    s_add_u32 m0, s80, 49152
    s_add_u32 s24, s78, 0
    buffer_load_dwordx4 v2, s[28:31], s24 offen nt lds
    s_add_u32 m0, s80, 53248
    s_add_u32 s24, s78, 40960
    buffer_load_dwordx4 v2, s[28:31], s24 offen nt lds
    s_add_u32 m0, s80, 57344
    s_add_u32 s24, s78, 81920
    buffer_load_dwordx4 v2, s[28:31], s24 offen nt lds
    s_add_u32 m0, s80, 61440
    s_add_u32 s24, s78, 122880
    buffer_load_dwordx4 v2, s[28:31], s24 offen nt lds
    s_add_u32 m0, s80, 65536
    s_add_u32 s24, s78, 163840
    buffer_load_dwordx4 v2, s[28:31], s24 offen nt lds
    s_add_u32 m0, s80, 69632
    s_add_u32 s24, s78, 204800
    buffer_load_dwordx4 v2, s[28:31], s24 offen nt lds
    s_waitcnt vmcnt(8)
    s_barrier
    s_add_u32 m0, s80, 106496
    s_add_u32 s24, s79, 0
    buffer_load_dwordx4 v3, s[32:35], s24 offen nt lds
    s_add_u32 m0, s80, 110592
    s_add_u32 s24, s79, 131072
    buffer_load_dwordx4 v3, s[32:35], s24 offen nt lds
    s_add_u32 m0, s80, 0
    s_mov_b32 s24, 0
    buffer_load_dwordx4 v4, s[40:43], s24 offen nt lds
    s_add_u32 m0, s80, 4096
    s_mov_b32 s24, 4096
    buffer_load_dwordx4 v4, s[40:43], s24 offen nt lds
    s_add_u32 m0, s80, 8192
    s_mov_b32 s24, 8192
    buffer_load_dwordx4 v4, s[40:43], s24 offen nt lds
    s_add_u32 m0, s80, 12288
    s_mov_b32 s24, 12288
    buffer_load_dwordx4 v4, s[40:43], s24 offen nt lds
    s_add_u32 m0, s80, 16384
    s_mov_b32 s24, 16384
    buffer_load_dwordx4 v4, s[40:43], s24 offen nt lds
    s_add_u32 m0, s80, 20480
    s_mov_b32 s24, 20480
    buffer_load_dwordx4 v4, s[40:43], s24 offen nt lds
    s_waitcnt vmcnt(14)
    s_barrier
    s_add_u32 m0, s80, 73728
    s_add_u32 s24, s79, 262144
    buffer_load_dwordx4 v3, s[32:35], s24 offen nt lds
    s_add_u32 m0, s80, 77824
    s_add_u32 s24, s79, 393216
    buffer_load_dwordx4 v3, s[32:35], s24 offen nt lds
    s_add_u32 s78, s78, 128
    s_cmp_eq_u32 s78, 1280
    s_cselect_b32 s78, 0, s78
    s_lshl_b32 s79, s78, 12
    s_add_u32 m0, s80, 24576
    s_add_u32 s24, s78, 0
    buffer_load_dwordx4 v2, s[28:31], s24 offen nt lds
    s_add_u32 m0, s80, 28672
    s_add_u32 s24, s78, 40960
    buffer_load_dwordx4 v2, s[28:31], s24 offen nt lds
    s_add_u32 m0, s80, 32768
    s_add_u32 s24, s78, 81920
    buffer_load_dwordx4 v2, s[28:31], s24 offen nt lds
    s_add_u32 m0, s80, 36864
    s_add_u32 s24, s78, 122880
    buffer_load_dwordx4 v2, s[28:31], s24 offen nt lds
    s_waitcnt vmcnt(12)
    s_barrier
    s_add_u32 m0, s80, 40960
    s_add_u32 s24, s78, 163840
    buffer_load_dwordx4 v2, s[28:31], s24 offen nt lds
    s_add_u32 m0, s80, 45056
    s_add_u32 s24, s78, 204800
    buffer_load_dwordx4 v2, s[28:31], s24 offen nt lds
    s_add_u32 m0, s80, 81920
    s_add_u32 s24, s79, 0
    buffer_load_dwordx4 v3, s[32:35], s24 offen nt lds
    s_add_u32 m0, s80, 86016
    s_add_u32 s24, s79, 131072
    buffer_load_dwordx4 v3, s[32:35], s24 offen nt lds
    s_add_u32 m0, s80, 90112
    s_add_u32 s24, s79, 262144
    buffer_load_dwordx4 v3, s[32:35], s24 offen nt lds
    s_add_u32 m0, s80, 94208
    s_add_u32 s24, s79, 393216
    buffer_load_dwordx4 v3, s[32:35], s24 offen nt lds
    s_mov_b32 s24, 786432
    buffer_load_dword v29, v26, s[40:43], s24 offen
    s_waitcnt vmcnt(11)
    s_barrier
    s_add_u32 s78, s78, 128
    s_cmp_eq_u32 s78, 1280
    s_cselect_b32 s78, 0, s78
    s_lshl_b32 s79, s78, 12
    s_add_u32 m0, s80, 49152
    s_add_u32 s24, s78, 0
    buffer_load_dwordx4 v2, s[28:31], s24 offen nt lds
    s_add_u32 m0, s80, 53248
    s_add_u32 s24, s78, 40960
    buffer_load_dwordx4 v2, s[28:31], s24 offen nt lds
    s_add_u32 m0, s80, 57344
    s_add_u32 s24, s78, 81920
    buffer_load_dwordx4 v2, s[28:31], s24 offen nt lds
    s_add_u32 m0, s80, 61440
    s_add_u32 s24, s78, 122880
    buffer_load_dwordx4 v2, s[28:31], s24 offen nt lds
    s_add_u32 m0, s80, 65536
    s_add_u32 s24, s78, 163840
    buffer_load_dwordx4 v2, s[28:31], s24 offen nt lds
    s_add_u32 m0, s80, 69632
    s_add_u32 s24, s78, 204800
    buffer_load_dwordx4 v2, s[28:31], s24 offen nt lds
    s_waitcnt vmcnt(9)
    s_barrier
    s_add_u32 m0, s80, 98304
    s_add_u32 s24, s79, 0
    buffer_load_dwordx4 v3, s[32:35], s24 offen nt lds
    s_add_u32 m0, s80, 102400
    s_add_u32 s24, s79, 131072
    buffer_load_dwordx4 v3, s[32:35], s24 offen nt lds
    s_waitcnt vmcnt(9)
    s_barrier
    s_add_u32 m0, s80, 106496
    s_add_u32 s24, s79, 262144
    buffer_load_dwordx4 v3, s[32:35], s24 offen nt lds
    s_add_u32 m0, s80, 110592
    s_add_u32 s24, s79, 393216
    buffer_load_dwordx4 v3, s[32:35], s24 offen nt lds
    s_add_u32 m0, s80, 24576
    s_mov_b32 s24, 786432
    buffer_load_dwordx4 v4, s[40:43], s24 offen nt lds
    s_add_u32 m0, s80, 28672
    s_mov_b32 s24, 790528
    buffer_load_dwordx4 v4, s[40:43], s24 offen nt lds
    s_add_u32 m0, s80, 32768
    s_mov_b32 s24, 794624
    buffer_load_dwordx4 v4, s[40:43], s24 offen nt lds
    s_add_u32 m0, s80, 36864
    s_mov_b32 s24, 798720
    buffer_load_dwordx4 v4, s[40:43], s24 offen nt lds
    s_add_u32 m0, s80, 40960
    s_mov_b32 s24, 802816
    buffer_load_dwordx4 v4, s[40:43], s24 offen nt lds
    buffer_load_dword v18, v17, s[68:71], 0 offen sc1
    s_add_u32 m0, s80, 45056
    s_mov_b32 s24, 806912
    buffer_load_dwordx4 v4, s[40:43], s24 offen nt lds
    s_waitcnt vmcnt(9)
    s_barrier
    s_add_u32 m0, s80, 81920
    s_add_u32 s24, s95, 0
    s_and_b32 s24, s24, 15
    s_mul_i32 s27, s24, 81920
    s_add_u32 s24, s27, 0
    buffer_load_dwordx4 v14, s[48:51], s24 offen lds
    s_add_u32 m0, s80, 86016
    s_add_u32 s24, s27, 20480
    buffer_load_dwordx4 v14, s[48:51], s24 offen lds
    s_add_u32 m0, s80, 90112
    s_add_u32 s24, s27, 40960
    buffer_load_dwordx4 v14, s[48:51], s24 offen lds
    s_add_u32 m0, s80, 94208
    s_add_u32 s24, s27, 61440
    buffer_load_dwordx4 v14, s[48:51], s24 offen lds
    s_waitcnt vmcnt(11)
    s_barrier
    s_add_u32 m0, s80, 49152
    s_add_u32 s24, s95, 1
    s_and_b32 s24, s24, 15
    s_mul_i32 s27, s24, 81920
    s_add_u32 s24, s27, 0
    buffer_load_dwordx4 v14, s[48:51], s24 offen lds
    s_add_u32 m0, s80, 53248
    s_add_u32 s24, s27, 20480
    buffer_load_dwordx4 v14, s[48:51], s24 offen lds
    s_add_u32 m0, s80, 57344
    s_add_u32 s24, s27, 40960
    buffer_load_dwordx4 v14, s[48:51], s24 offen lds
    s_add_u32 m0, s80, 61440
    s_add_u32 s24, s27, 61440
    buffer_load_dwordx4 v14, s[48:51], s24 offen lds
    s_barrier
    s_add_u32 m0, s80, 65536
    s_add_u32 s24, s95, 2
    s_and_b32 s24, s24, 15
    s_mul_i32 s27, s24, 81920
    s_add_u32 s24, s27, 0
    buffer_load_dwordx4 v14, s[48:51], s24 offen lds
    s_add_u32 m0, s80, 69632
    s_add_u32 s24, s27, 20480
    buffer_load_dwordx4 v14, s[48:51], s24 offen lds
    s_add_u32 m0, s80, 73728
    s_add_u32 s24, s27, 40960
    buffer_load_dwordx4 v14, s[48:51], s24 offen lds
    s_add_u32 m0, s80, 77824
    s_add_u32 s24, s27, 61440
    buffer_load_dwordx4 v14, s[48:51], s24 offen lds
    s_add_u32 m0, s80, 98304
    s_add_u32 s24, s95, 3
    s_and_b32 s24, s24, 15
    s_mul_i32 s27, s24, 81920
    s_add_u32 s24, s27, 0
    buffer_load_dwordx4 v14, s[48:51], s24 offen lds
    s_add_u32 m0, s80, 102400
    s_add_u32 s24, s27, 20480
    buffer_load_dwordx4 v14, s[48:51], s24 offen lds
    s_add_u32 m0, s80, 106496
    s_add_u32 s24, s27, 40960
    buffer_load_dwordx4 v14, s[48:51], s24 offen lds
    s_add_u32 m0, s80, 110592
    s_add_u32 s24, s27, 61440
    buffer_load_dwordx4 v14, s[48:51], s24 offen lds
    s_waitcnt vmcnt(16)
    v_cmp_ne_u32 vcc, 1, v18
    s_cbranch_vccz L_cnt2_ok
L_cnt2:
    buffer_load_dword v18, v17, s[68:71], 0 offen sc1
    s_add_u32 s98, s98, 0x2000
    s_cbranch_scc1 L_done
    s_waitcnt vmcnt(0)
    v_cmp_ne_u32 vcc, 1, v18
    s_cbranch_vccnz L_cnt2
L_cnt2_ok:
    s_barrier
    s_cmp_ge_u32 s86, 30
    s_cbranch_scc1 L_idle
    buffer_load_dword v29, v19, s[64:67], s91 offen sc1
    s_add_u32 m0, s80, 114688
    s_add_u32 s24, s95, 9
    s_and_b32 s24, s24, 15
    s_mul_i32 s27, s24, 81920
    s_add_u32 s24, s27, 0
    buffer_load_dwordx4 v14, s[48:51], s24 offen lds
    s_add_u32 m0, s80, 118784
    s_add_u32 s24, s27, 20480
    buffer_load_dwordx4 v14, s[48:51], s24 offen lds
    s_add_u32 m0, s80, 122880
    s_add_u32 s24, s27, 40960
    buffer_load_dwordx4 v14, s[48:51], s24 offen lds
    s_add_u32 m0, s80, 126976
    s_add_u32 s24, s27, 61440
    buffer_load_dwordx4 v14, s[48:51], s24 offen lds
    s_add_u32 m0, s80, 131072
    s_add_u32 s24, s95, 15
    s_and_b32 s24, s24, 15
    s_mul_i32 s27, s24, 81920
    s_add_u32 s24, s27, 0
    buffer_load_dwordx4 v14, s[48:51], s24 offen lds
    s_add_u32 m0, s80, 135168
    s_add_u32 s24, s27, 20480
    buffer_load_dwordx4 v14, s[48:51], s24 offen lds
    s_add_u32 m0, s80, 139264
    s_add_u32 s24, s27, 40960
    buffer_load_dwordx4 v14, s[48:51], s24 offen lds
    s_add_u32 m0, s80, 143360
    s_add_u32 s24, s27, 61440
    buffer_load_dwordx4 v14, s[48:51], s24 offen lds
    s_waitcnt vmcnt(0)
    s_barrier
    s_add_u32 m0, s80, 0
    s_add_u32 s24, s95, 4
    s_and_b32 s24, s24, 15
    s_mul_i32 s27, s24, 81920
    s_add_u32 s24, s27, 0
    buffer_load_dwordx4 v14, s[48:51], s24 offen lds
    s_add_u32 m0, s80, 4096
    s_add_u32 s24, s27, 20480
    buffer_load_dwordx4 v14, s[48:51], s24 offen lds
    s_add_u32 m0, s80, 8192
    s_add_u32 s24, s27, 40960
    buffer_load_dwordx4 v14, s[48:51], s24 offen lds
    s_add_u32 m0, s80, 12288
    s_add_u32 s24, s27, 61440
    buffer_load_dwordx4 v14, s[48:51], s24 offen lds
    s_add_u32 m0, s80, 16384
    s_add_u32 s24, s95, 5
    s_and_b32 s24, s24, 15
    s_mul_i32 s27, s24, 81920
    s_add_u32 s24, s27, 0
    buffer_load_dwordx4 v14, s[48:51], s24 offen lds
    s_add_u32 m0, s80, 20480
    s_add_u32 s24, s27, 20480
    buffer_load_dwordx4 v14, s[48:51], s24 offen lds
    s_add_u32 m0, s80, 24576
    s_add_u32 s24, s27, 40960
    buffer_load_dwordx4 v14, s[48:51], s24 offen lds
    s_add_u32 m0, s80, 28672
    s_add_u32 s24, s27, 61440
    buffer_load_dwordx4 v14, s[48:51], s24 offen lds
    s_add_u32 m0, s80, 32768
    s_add_u32 s24, s95, 6
    s_and_b32 s24, s24, 15
    s_mul_i32 s27, s24, 81920
    s_add_u32 s24, s27, 0
    buffer_load_dwordx4 v14, s[48:51], s24 offen lds
    s_add_u32 m0, s80, 36864
    s_add_u32 s24, s27, 20480
    buffer_load_dwordx4 v14, s[48:51], s24 offen lds
    s_add_u32 m0, s80, 40960
    s_add_u32 s24, s27, 40960
    buffer_load_dwordx4 v14, s[48:51], s24 offen lds
    s_add_u32 m0, s80, 45056
    s_add_u32 s24, s27, 61440
    buffer_load_dwordx4 v14, s[48:51], s24 offen lds
    s_branch L_common
.p2alignl 12, 0xbf810000
L_compute:
    v_lshlrev_b32 v36, 4, v0
    s_waitcnt lgkmcnt(0)
    s_cmpk_lg_u32 s86, 30
    s_cbranch_scc1 L_noclear
    s_and_b32 s24, s2, 7
    s_lshl2_add_u32 s24, s24, s23
    s_lshl_b32 s25, s24, 12
    s_lshl_b32 s26, s24, 9
    s_add_u32 s26, s26, 261632
    s_mov_b32 s24, 33554432
    s_add_u32 s32, s14, s24
    s_addc_u32 s33, s15, 0
    s_mov_b32 s34, 278528
    s_mov_b32 s35, 0x20000
    v_lshl_add_u32 v8, v0, 7, s25
    v_add_u32 v9, s26, v36
    v_cmp_gt_u32 vcc, 32, v0
    v_mov_b32 v4, 0
    v_mov_b32 v5, 0
    v_mov_b32 v6, 0
    v_mov_b32 v7, 0
    v_mov_b32 v8, 0x7fffffff
    v_cndmask_b32 v8, v9, v8, vcc
    buffer_store_dwordx4 v[4:7], v8, s[32:35], 0 offen sc1
    s_and_b32 s25, s2, 7
    s_lshl_b32 s25, s25, 14
    s_lshl_b32 s26, s23, 12
    s_add_u32 s25, s25, s26
    buffer_store_dwordx4 v[4:7], v36, s[32:35], s25 offen sc1
    buffer_store_dwordx4 v[4:7], v36, s[32:35], s25 offen offset:1024 sc1
    buffer_store_dwordx4 v[4:7], v36, s[32:35], s25 offen offset:2048 sc1
    buffer_store_dwordx4 v[4:7], v36, s[32:35], s25 offen offset:3072 sc1
    s_nop 1
L_noclear:
    s_mul_i32 s85, s86, 43
    s_lshr_b32 s85, s85, 8
    s_mul_i32 s25, s85, 6
    s_sub_u32 s84, s86, s25
    s_lshl_b32 s88, s23, 10
    s_mul_i32 s24, s20, 6
    s_add_u32 s24, s24, s84
    s_lshl_b32 s24, s24, 5
    s_add_u32 s24, s24, s83
    s_lshl_b32 s24, s24, 15
    s_add_u32 s44, s14, s24
    s_addc_u32 s45, s15, 0
    s_mov_b32 s46, 950272
    s_mov_b32 s47, 0x20000
    s_mul_i32 s24, s83, 1310720
    s_lshl_b32 s26, s85, 8
    s_add_u32 s24, s24, s26
    s_cmp_lt_u32 s86, 30
    s_cselect_b32 s26, 1309696, 0
    s_add_u32 s48, s12, s24
    s_addc_u32 s49, s13, 0
    s_mov_b32 s50, s26
    s_mov_b32 s51, 0x20000
    s_mul_i32 s24, s20, 30
    s_add_u32 s24, s24, s86
    s_lshl_b32 s24, s24, 17
    s_add_u32 s24, s24, s88
    s_add_u32 s24, s24, 16777216
    s_add_u32 s52, s14, s24
    s_addc_u32 s53, s15, 0
    s_mov_b32 s54, 123904
    s_mov_b32 s55, 0x20000
    s_lshl_b32 s24, s20, 16
    s_add_u32 s24, s24, 33554432
    s_add_u32 s64, s14, s24
    s_addc_u32 s65, s15, 0
    s_mov_b32 s66, 278528
    s_mov_b32 s67, 0x20000
    s_mul_i32 s91, s20, 4294909952
    s_add_u32 s91, s91, 262144
    s_and_b32 s25, s23, 3
    s_lshl_b32 s24, s22, 2
    s_add_u32 s24, s24, s25
    s_and_b32 s26, s21, 7
    s_mul_i32 s93, s24, 24
    s_add_u32 s93, s93, s26
    s_lshl_b32 s93, s93, 2
    s_lshl_b32 s27, s83, 11
    s_add_u32 s93, s93, s27
    s_add_u32 s93, s93, s91
    s_lshl3_add_u32 s24, s22, s26
    s_lshl2_add_u32 s24, s24, s25
    s_lshl_b32 s24, s24, 7
    s_lshl_b32 s27, s83, 14
    s_add_u32 s92, s24, s27
    s_and_b32 s25, s23, 4
    s_add_u32 s94, s24, s25
    s_lshl2_add_u32 s24, s84, s83
    s_mul_i32 s24, s24, 81920
    s_mul_i32 s25, s20, 40
    s_lshl3_add_u32 s25, s85, s25
    s_add_u32 s25, s25, s23
    s_lshl_b32 s25, s25, 5
    s_add_u32 s24, s24, s25
    s_add_u32 s56, s16, s24
    s_addc_u32 s57, s17, 0
    s_mov_b32 s58, 79392
    s_mov_b32 s59, 0x20000
    s_lshl_b32 s24, s84, 2
    s_lshr_b32 s24, 0xdb8530, s24
    s_mul_i32 s25, s85, 0
    s_add_u32 s24, s24, s25
    s_and_b32 s95, s24, 15
    v_and_b32 v1, 15, v0
    v_lshrrev_b32 v2, 4, v0
    s_mul_i32 s24, s23, 6144
    v_lshrrev_b32 v3, 1, v1
    v_xor_b32 v3, v2, v3
    v_lshlrev_b32 v3, 4, v3
    v_lshlrev_b32 v4, 7, v1
    v_add_u32 v3, v3, v4
    v_add_u32 v10, s24, v3
    v_xor_b32 v11, 64, v10
    v_lshrrev_b32 v3, 2, v0
    v_and_b32 v4, 7, v3
    v_lshlrev_b32 v4, 5, v4
    v_lshlrev_b32 v3, 8, v3
    v_add_u32 v3, v3, v4
    v_and_b32 v4, 3, v0
    v_lshlrev_b32 v4, 3, v4
    v_add_u32 v37, v3, v4
    v_lshl_add_u32 v3, v2, 10, v37
    v_add_u32 v12, 73728, v3
    s_cmp_lt_u32 s23, 2
    s_cselect_b32 s25, 0, 24576
    s_add_u32 s24, s25, 0
    s_add_u32 s25, s25, 114688
    v_add_u32 v28, s24, v37
    v_lshrrev_b32 v3, 1, v2
    v_xor_b32 v3, v3, v1
    v_lshlrev_b32 v3, 4, v3
    v_lshlrev_b32 v4, 8, v1
    v_add_u32 v3, v3, v4
    v_and_b32 v4, 1, v2
    v_lshlrev_b32 v4, 3, v4
    v_add_u32 v3, v3, v4
    v_add_u32 v20, s25, v3
    v_xor_b32 v13, 32, v12
    v_xor_b32 v29, 32, v28
    v_xor_b32 v21, 32, v20
    v_xor_b32 v14, 64, v12
    v_xor_b32 v30, 64, v28
    v_xor_b32 v22, 64, v20
    v_xor_b32 v15, 96, v12
    v_xor_b32 v31, 96, v28
    v_xor_b32 v23, 96, v20
    v_xor_b32 v16, 128, v12
    v_xor_b32 v32, 128, v28
    v_xor_b32 v24, 128, v20
    v_xor_b32 v17, 160, v12
    v_xor_b32 v33, 160, v28
    v_xor_b32 v25, 160, v20
    v_xor_b32 v18, 192, v12
    v_xor_b32 v34, 192, v28
    v_xor_b32 v26, 192, v20
    v_xor_b32 v19, 224, v12
    v_xor_b32 v35, 224, v28
    v_xor_b32 v27, 224, v20
    s_mul_i32 s24, s20, 48
    s_mul_i32 s25, s22, 12
    s_add_u32 s24, s24, s25
    s_mul_i32 s25, s23, 3
    s_add_u32 s24, s24, s25
    s_lshl_b32 s24, s24, 5
    s_add_u32 s24, s24, s21
    s_lshl_b32 s24, s24, 12
    s_mov_b32 s81, 131072
    s_mov_b32 s82, 262144
    s_mov_b32 s76, 0x3e0293ee
    s_mov_b32 s77, 0x3e0293ee
    s_add_u32 s28, s14, s24
    s_addc_u32 s29, s15, 0
    s_mov_b32 s30, 266240
    s_mov_b32 s31, 0x20000
    s_mov_b64 exec, 0
    s_cmp_eq_u32 s23, 0
    s_cbranch_scc1 L_walk0
    s_cmp_eq_u32 s23, 1
    s_cbranch_scc1 L_walk1
    s_cmp_eq_u32 s23, 2
    s_cbranch_scc1 L_walk2
    s_branch L_walk3
L_walked:
    s_mov_b64 exec, -1
    s_cmpk_eq_u32 s86, 30
    s_waitcnt vmcnt(5)
    s_cbranch_scc1 L_first_in
    s_waitcnt vmcnt(0)
L_first_in:
    s_barrier
    ds_read_b128 v[168:171], v10 offset:49152
    ds_read_b128 v[172:175], v10 offset:51200
    ds_read_b128 v[176:179], v10 offset:53248
    ds_read_b64_tr_b16 v[136:137], v12
    ds_read_b64_tr_b16 v[138:139], v12 offset:1024
    ds_read_b64_tr_b16 v[140:141], v13
    ds_read_b64_tr_b16 v[142:143], v13 offset:1024
    ds_read_b128 v[180:183], v11 offset:49152
    ds_read_b128 v[184:187], v11 offset:51200
    ds_read_b128 v[188:191], v11 offset:53248
    ds_read_b64_tr_b16 v[144:145], v14
    ds_read_b64_tr_b16 v[146:147], v14 offset:1024
    ds_read_b64_tr_b16 v[148:149], v15
    ds_read_b64_tr_b16 v[150:151], v15 offset:1024
    ds_read_b64_tr_b16 v[152:153], v16
    ds_read_b64_tr_b16 v[154:155], v16 offset:1024
    ds_read_b64_tr_b16 v[156:157], v17
    ds_read_b64_tr_b16 v[158:159], v17 offset:1024
    ds_read_b64_tr_b16 v[160:161], v18
    ds_read_b64_tr_b16 v[162:163], v18 offset:1024
    s_waitcnt lgkmcnt(15)
    v_mfma_f32_16x16x32_bf16 v[40:43], v[136:139], v[168:171], 0
    ds_read_b64_tr_b16 v[164:165], v19
    v_mfma_f32_16x16x32_bf16 v[44:47], v[136:139], v[172:175], 0
    ds_read_b64_tr_b16 v[166:167], v19 offset:1024
    v_mfma_f32_16x16x32_bf16 v[48:51], v[136:139], v[176:179], 0
    s_waitcnt lgkmcnt(15)
    v_mfma_f32_16x16x32_bf16 v[60:63], v[140:143], v[176:179], 0
    v_mfma_f32_16x16x32_bf16 v[56:59], v[140:143], v[172:175], 0
    v_mfma_f32_16x16x32_bf16 v[52:55], v[140:143], v[168:171], 0
    s_waitcnt lgkmcnt(0)
    s_barrier
    v_mfma_f32_16x16x32_bf16 v[64:67], v[144:147], v[168:171], 0
    ds_read_b64_tr_b16 v[136:137], v12 offset:8192
    ds_read_b64_tr_b16 v[138:139], v12 offset:9216
    v_mfma_f32_16x16x32_bf16 v[68:71], v[144:147], v[172:175], 0
    ds_read_b64_tr_b16 v[140:141], v13 offset:8192
    ds_read_b64_tr_b16 v[142:143], v13 offset:9216
    v_mfma_f32_16x16x32_bf16 v[72:75], v[144:147], v[176:179], 0
    v_mfma_f32_16x16x32_bf16 v[84:87], v[148:151], v[176:179], 0
    ds_read_b64_tr_b16 v[144:145], v14 offset:8192
    v_mfma_f32_16x16x32_bf16 v[80:83], v[148:151], v[172:175], 0
    ds_read_b64_tr_b16 v[146:147], v14 offset:9216
    v_mfma_f32_16x16x32_bf16 v[76:79], v[148:151], v[168:171], 0
    v_mfma_f32_16x16x32_bf16 v[88:91], v[152:155], v[168:171], 0
    ds_read_b64_tr_b16 v[148:149], v15 offset:8192
    v_mfma_f32_16x16x32_bf16 v[92:95], v[152:155], v[172:175], 0
    ds_read_b64_tr_b16 v[150:151], v15 offset:9216
    v_mfma_f32_16x16x32_bf16 v[96:99], v[152:155], v[176:179], 0
    v_mfma_f32_16x16x32_bf16 v[108:111], v[156:159], v[176:179], 0
    ds_read_b64_tr_b16 v[152:153], v16 offset:8192
    v_mfma_f32_16x16x32_bf16 v[104:107], v[156:159], v[172:175], 0
    ds_read_b64_tr_b16 v[154:155], v16 offset:9216
    v_mfma_f32_16x16x32_bf16 v[100:103], v[156:159], v[168:171], 0
    v_mfma_f32_16x16x32_bf16 v[112:115], v[160:163], v[168:171], 0
    ds_read_b64_tr_b16 v[156:157], v17 offset:8192
    v_mfma_f32_16x16x32_bf16 v[116:119], v[160:163], v[172:175], 0
    ds_read_b64_tr_b16 v[158:159], v17 offset:9216
    v_mfma_f32_16x16x32_bf16 v[120:123], v[160:163], v[176:179], 0
    v_mfma_f32_16x16x32_bf16 v[132:135], v[164:167], v[176:179], 0
    ds_read_b64_tr_b16 v[160:161], v18 offset:8192
    v_mfma_f32_16x16x32_bf16 v[128:131], v[164:167], v[172:175], 0
    ds_read_b64_tr_b16 v[162:163], v18 offset:9216
    v_mfma_f32_16x16x32_bf16 v[124:127], v[164:167], v[168:171], 0
    s_waitcnt lgkmcnt(12)
    v_mfma_f32_16x16x32_bf16 v[40:43], v[136:139], v[180:183], v[40:43]
    ds_read_b64_tr_b16 v[164:165], v19 offset:8192
    v_mfma_f32_16x16x32_bf16 v[44:47], v[136:139], v[184:187], v[44:47]
    ds_read_b64_tr_b16 v[166:167], v19 offset:9216
    v_mfma_f32_16x16x32_bf16 v[48:51], v[136:139], v[188:191], v[48:51]
    s_waitcnt lgkmcnt(12)
    v_mfma_f32_16x16x32_bf16 v[60:63], v[140:143], v[188:191], v[60:63]
    v_mfma_f32_16x16x32_bf16 v[56:59], v[140:143], v[184:187], v[56:59]
    v_mfma_f32_16x16x32_bf16 v[52:55], v[140:143], v[180:183], v[52:55]
    s_waitcnt lgkmcnt(0)
    s_barrier
    v_mfma_f32_16x16x32_bf16 v[64:67], v[144:147], v[180:183], v[64:67]
    ds_read_b64_tr_b16 v[136:137], v12 offset:16384
    ds_read_b64_tr_b16 v[138:139], v12 offset:17408
    v_mfma_f32_16x16x32_bf16 v[68:71], v[144:147], v[184:187], v[68:71]
    ds_read_b64_tr_b16 v[140:141], v13 offset:16384
    ds_read_b64_tr_b16 v[142:143], v13 offset:17408
    v_mfma_f32_16x16x32_bf16 v[72:75], v[144:147], v[188:191], v[72:75]
    ds_read_b128 v[168:171], v10
    ds_read_b128 v[172:175], v10 offset:2048
    v_mfma_f32_16x16x32_bf16 v[84:87], v[148:151], v[188:191], v[84:87]
    ds_read_b64_tr_b16 v[144:145], v14 offset:16384
    v_mfma_f32_16x16x32_bf16 v[80:83], v[148:151], v[184:187], v[80:83]
    ds_read_b64_tr_b16 v[146:147], v14 offset:17408
    v_mfma_f32_16x16x32_bf16 v[76:79], v[148:151], v[180:183], v[76:79]
    ds_read_b128 v[176:179], v10 offset:4096
    v_mfma_f32_16x16x32_bf16 v[88:91], v[152:155], v[180:183], v[88:91]
    ds_read_b64_tr_b16 v[148:149], v15 offset:16384
    v_mfma_f32_16x16x32_bf16 v[92:95], v[152:155], v[184:187], v[92:95]
    ds_read_b64_tr_b16 v[150:151], v15 offset:17408
    v_mfma_f32_16x16x32_bf16 v[96:99], v[152:155], v[188:191], v[96:99]
    ds_read_b128 v[192:195], v11
    v_mfma_f32_16x16x32_bf16 v[108:111], v[156:159], v[188:191], v[108:111]
    ds_read_b64_tr_b16 v[152:153], v16 offset:16384
    v_mfma_f32_16x16x32_bf16 v[104:107], v[156:159], v[184:187], v[104:107]
    ds_read_b64_tr_b16 v[154:155], v16 offset:17408
    v_mfma_f32_16x16x32_bf16 v[100:103], v[156:159], v[180:183], v[100:103]
    ds_read_b128 v[196:199], v11 offset:2048
    v_mfma_f32_16x16x32_bf16 v[112:115], v[160:163], v[180:183], v[112:115]
    ds_read_b64_tr_b16 v[156:157], v17 offset:16384
    v_mfma_f32_16x16x32_bf16 v[116:119], v[160:163], v[184:187], v[116:119]
    ds_read_b64_tr_b16 v[158:159], v17 offset:17408
    v_mfma_f32_16x16x32_bf16 v[120:123], v[160:163], v[188:191], v[120:123]
    ds_read_b128 v[200:203], v11 offset:4096
    v_mfma_f32_16x16x32_bf16 v[132:135], v[164:167], v[188:191], v[132:135]
    ds_read_b64_tr_b16 v[160:161], v18 offset:16384
    v_mfma_f32_16x16x32_bf16 v[128:131], v[164:167], v[184:187], v[128:131]
    ds_read_b64_tr_b16 v[162:163], v18 offset:17408
    v_mfma_f32_16x16x32_bf16 v[124:127], v[164:167], v[180:183], v[124:127]
    s_waitcnt lgkmcnt(15)
    v_mfma_f32_16x16x32_bf16 v[40:43], v[136:139], v[168:171], v[40:43]
    ds_read_b64_tr_b16 v[164:165], v19 offset:16384
    s_waitcnt lgkmcnt(15)
    v_mfma_f32_16x16x32_bf16 v[44:47], v[136:139], v[172:175], v[44:47]
    ds_read_b64_tr_b16 v[166:167], v19 offset:17408
    s_waitcnt lgkmcnt(13)
    v_mfma_f32_16x16x32_bf16 v[48:51], v[136:139], v[176:179], v[48:51]
    v_mfma_f32_16x16x32_bf16 v[60:63], v[140:143], v[176:179], v[60:63]
    v_mfma_f32_16x16x32_bf16 v[56:59], v[140:143], v[172:175], v[56:59]
    v_mfma_f32_16x16x32_bf16 v[52:55], v[140:143], v[168:171], v[52:55]
    s_waitcnt lgkmcnt(0)
    s_barrier
    v_mfma_f32_16x16x32_bf16 v[64:67], v[144:147], v[168:171], v[64:67]
    ds_read_b64_tr_b16 v[136:137], v12 offset:24576
    ds_read_b64_tr_b16 v[138:139], v12 offset:25600
    v_mfma_f32_16x16x32_bf16 v[68:71], v[144:147], v[172:175], v[68:71]
    ds_read_b64_tr_b16 v[140:141], v13 offset:24576
    ds_read_b64_tr_b16 v[142:143], v13 offset:25600
    v_mfma_f32_16x16x32_bf16 v[72:75], v[144:147], v[176:179], v[72:75]
    v_mfma_f32_16x16x32_bf16 v[84:87], v[148:151], v[176:179], v[84:87]
    ds_read_b64_tr_b16 v[144:145], v14 offset:24576
    v_mfma_f32_16x16x32_bf16 v[80:83], v[148:151], v[172:175], v[80:83]
    ds_read_b64_tr_b16 v[146:147], v14 offset:25600
    v_mfma_f32_16x16x32_bf16 v[76:79], v[148:151], v[168:171], v[76:79]
    v_mfma_f32_16x16x32_bf16 v[88:91], v[152:155], v[168:171], v[88:91]
    ds_read_b64_tr_b16 v[148:149], v15 offset:24576
    v_mfma_f32_16x16x32_bf16 v[92:95], v[152:155], v[172:175], v[92:95]
    ds_read_b64_tr_b16 v[150:151], v15 offset:25600
    v_mfma_f32_16x16x32_bf16 v[96:99], v[152:155], v[176:179], v[96:99]
    v_mfma_f32_16x16x32_bf16 v[108:111], v[156:159], v[176:179], v[108:111]
    ds_read_b64_tr_b16 v[152:153], v16 offset:24576
    v_mfma_f32_16x16x32_bf16 v[104:107], v[156:159], v[172:175], v[104:107]
    ds_read_b64_tr_b16 v[154:155], v16 offset:25600
    v_mfma_f32_16x16x32_bf16 v[100:103], v[156:159], v[168:171], v[100:103]
    v_mfma_f32_16x16x32_bf16 v[112:115], v[160:163], v[168:171], v[112:115]
    ds_read_b64_tr_b16 v[156:157], v17 offset:24576
    v_mfma_f32_16x16x32_bf16 v[116:119], v[160:163], v[172:175], v[116:119]
    ds_read_b64_tr_b16 v[158:159], v17 offset:25600
    v_mfma_f32_16x16x32_bf16 v[120:123], v[160:163], v[176:179], v[120:123]
    v_mfma_f32_16x16x32_bf16 v[132:135], v[164:167], v[176:179], v[132:135]
    ds_read_b64_tr_b16 v[160:161], v18 offset:24576
    v_mfma_f32_16x16x32_bf16 v[128:131], v[164:167], v[172:175], v[128:131]
    ds_read_b64_tr_b16 v[162:163], v18 offset:25600
    v_mfma_f32_16x16x32_bf16 v[124:127], v[164:167], v[168:171], v[124:127]
    s_waitcnt lgkmcnt(12)
    v_mfma_f32_16x16x32_bf16 v[40:43], v[136:139], v[192:195], v[40:43]
    ds_read_b64_tr_b16 v[164:165], v19 offset:24576
    v_mfma_f32_16x16x32_bf16 v[44:47], v[136:139], v[196:199], v[44:47]
    ds_read_b64_tr_b16 v[166:167], v19 offset:25600
    v_mfma_f32_16x16x32_bf16 v[48:51], v[136:139], v[200:203], v[48:51]
    s_waitcnt lgkmcnt(12)
    v_mfma_f32_16x16x32_bf16 v[60:63], v[140:143], v[200:203], v[60:63]
    v_mfma_f32_16x16x32_bf16 v[56:59], v[140:143], v[196:199], v[56:59]
    v_mfma_f32_16x16x32_bf16 v[52:55], v[140:143], v[192:195], v[52:55]
    s_waitcnt lgkmcnt(0)
    s_barrier
    v_mfma_f32_16x16x32_bf16 v[64:67], v[144:147], v[192:195], v[64:67]
    ds_read_b64_tr_b16 v[136:137], v12 offset:32768
    ds_read_b64_tr_b16 v[138:139], v12 offset:33792
    v_mfma_f32_16x16x32_bf16 v[68:71], v[144:147], v[196:199], v[68:71]
    ds_read_b64_tr_b16 v[140:141], v13 offset:32768
    ds_read_b64_tr_b16 v[142:143], v13 offset:33792
    v_mfma_f32_16x16x32_bf16 v[72:75], v[144:147], v[200:203], v[72:75]
    ds_read_b128 v[168:171], v10 offset:24576
    ds_read_b128 v[172:175], v10 offset:26624
    v_mfma_f32_16x16x32_bf16 v[84:87], v[148:151], v[200:203], v[84:87]
    ds_read_b64_tr_b16 v[144:145], v14 offset:32768
    v_mfma_f32_16x16x32_bf16 v[80:83], v[148:151], v[196:199], v[80:83]
    ds_read_b64_tr_b16 v[146:147], v14 offset:33792
    v_mfma_f32_16x16x32_bf16 v[76:79], v[148:151], v[192:195], v[76:79]
    ds_read_b128 v[176:179], v10 offset:28672
    v_mfma_f32_16x16x32_bf16 v[88:91], v[152:155], v[192:195], v[88:91]
    ds_read_b64_tr_b16 v[148:149], v15 offset:32768
    v_mfma_f32_16x16x32_bf16 v[92:95], v[152:155], v[196:199], v[92:95]
    ds_read_b64_tr_b16 v[150:151], v15 offset:33792
    v_mfma_f32_16x16x32_bf16 v[96:99], v[152:155], v[200:203], v[96:99]
    ds_read_b128 v[180:183], v11 offset:24576
    v_mfma_f32_16x16x32_bf16 v[108:111], v[156:159], v[200:203], v[108:111]
    ds_read_b64_tr_b16 v[152:153], v16 offset:32768
    v_mfma_f32_16x16x32_bf16 v[104:107], v[156:159], v[196:199], v[104:107]
    ds_read_b64_tr_b16 v[154:155], v16 offset:33792
    v_mfma_f32_16x16x32_bf16 v[100:103], v[156:159], v[192:195], v[100:103]
    ds_read_b128 v[184:187], v11 offset:26624
    v_mfma_f32_16x16x32_bf16 v[112:115], v[160:163], v[192:195], v[112:115]
    ds_read_b64_tr_b16 v[156:157], v17 offset:32768
    v_mfma_f32_16x16x32_bf16 v[116:119], v[160:163], v[196:199], v[116:119]
    ds_read_b64_tr_b16 v[158:159], v17 offset:33792
    v_mfma_f32_16x16x32_bf16 v[120:123], v[160:163], v[200:203], v[120:123]
    ds_read_b128 v[188:191], v11 offset:28672
    v_mfma_f32_16x16x32_bf16 v[132:135], v[164:167], v[200:203], v[132:135]
    ds_read_b64_tr_b16 v[160:161], v18 offset:32768
    v_mfma_f32_16x16x32_bf16 v[128:131], v[164:167], v[196:199], v[128:131]
    ds_read_b64_tr_b16 v[162:163], v18 offset:33792
    v_mfma_f32_16x16x32_bf16 v[124:127], v[164:167], v[192:195], v[124:127]
    s_waitcnt lgkmcnt(15)
    v_mfma_f32_16x16x32_bf16 v[40:43], v[136:139], v[168:171], v[40:43]
    ds_read_b64_tr_b16 v[164:165], v19 offset:32768
    s_waitcnt lgkmcnt(15)
    v_mfma_f32_16x16x32_bf16 v[44:47], v[136:139], v[172:175], v[44:47]
    ds_read_b64_tr_b16 v[166:167], v19 offset:33792
    s_waitcnt lgkmcnt(13)
    v_mfma_f32_16x16x32_bf16 v[48:51], v[136:139], v[176:179], v[48:51]
    v_mfma_f32_16x16x32_bf16 v[60:63], v[140:143], v[176:179], v[60:63]
    v_mfma_f32_16x16x32_bf16 v[56:59], v[140:143], v[172:175], v[56:59]
    v_mfma_f32_16x16x32_bf16 v[52:55], v[140:143], v[168:171], v[52:55]
    s_waitcnt lgkmcnt(0)
    s_barrier
    v_mfma_f32_16x16x32_bf16 v[64:67], v[144:147], v[168:171], v[64:67]
    ds_read_b64_tr_b16 v[136:137], v12
    ds_read_b64_tr_b16 v[138:139], v12 offset:1024
    v_mfma_f32_16x16x32_bf16 v[68:71], v[144:147], v[172:175], v[68:71]
    ds_read_b64_tr_b16 v[140:141], v13
    ds_read_b64_tr_b16 v[142:143], v13 offset:1024
    v_mfma_f32_16x16x32_bf16 v[72:75], v[144:147], v[176:179], v[72:75]
    v_mfma_f32_16x16x32_bf16 v[84:87], v[148:151], v[176:179], v[84:87]
    ds_read_b64_tr_b16 v[144:145], v14
    v_mfma_f32_16x16x32_bf16 v[80:83], v[148:151], v[172:175], v[80:83]
    ds_read_b64_tr_b16 v[146:147], v14 offset:1024
    v_mfma_f32_16x16x32_bf16 v[76:79], v[148:151], v[168:171], v[76:79]
    v_mfma_f32_16x16x32_bf16 v[88:91], v[152:155], v[168:171], v[88:91]
    ds_read_b64_tr_b16 v[148:149], v15
    v_mfma_f32_16x16x32_bf16 v[92:95], v[152:155], v[172:175], v[92:95]
    ds_read_b64_tr_b16 v[150:151], v15 offset:1024
    v_mfma_f32_16x16x32_bf16 v[96:99], v[152:155], v[176:179], v[96:99]
    v_mfma_f32_16x16x32_bf16 v[108:111], v[156:159], v[176:179], v[108:111]
    ds_read_b64_tr_b16 v[152:153], v16
    v_mfma_f32_16x16x32_bf16 v[104:107], v[156:159], v[172:175], v[104:107]
    ds_read_b64_tr_b16 v[154:155], v16 offset:1024
    v_mfma_f32_16x16x32_bf16 v[100:103], v[156:159], v[168:171], v[100:103]
    v_mfma_f32_16x16x32_bf16 v[112:115], v[160:163], v[168:171], v[112:115]
    ds_read_b64_tr_b16 v[156:157], v17
    v_mfma_f32_16x16x32_bf16 v[116:119], v[160:163], v[172:175], v[116:119]
    ds_read_b64_tr_b16 v[158:159], v17 offset:1024
    v_mfma_f32_16x16x32_bf16 v[120:123], v[160:163], v[176:179], v[120:123]
    v_mfma_f32_16x16x32_bf16 v[132:135], v[164:167], v[176:179], v[132:135]
    ds_read_b64_tr_b16 v[160:161], v18
    v_mfma_f32_16x16x32_bf16 v[128:131], v[164:167], v[172:175], v[128:131]
    ds_read_b64_tr_b16 v[162:163], v18 offset:1024
    v_mfma_f32_16x16x32_bf16 v[124:127], v[164:167], v[168:171], v[124:127]
    s_waitcnt lgkmcnt(12)
    v_mfma_f32_16x16x32_bf16 v[40:43], v[136:139], v[180:183], v[40:43]
    ds_read_b64_tr_b16 v[164:165], v19
    v_mfma_f32_16x16x32_bf16 v[44:47], v[136:139], v[184:187], v[44:47]
    ds_read_b64_tr_b16 v[166:167], v19 offset:1024
    v_mfma_f32_16x16x32_bf16 v[48:51], v[136:139], v[188:191], v[48:51]
    s_waitcnt lgkmcnt(12)
    v_mfma_f32_16x16x32_bf16 v[60:63], v[140:143], v[188:191], v[60:63]
    v_mfma_f32_16x16x32_bf16 v[56:59], v[140:143], v[184:187], v[56:59]
    v_mfma_f32_16x16x32_bf16 v[52:55], v[140:143], v[180:183], v[52:55]
    s_waitcnt vmcnt(0) lgkmcnt(0)
    s_barrier
    v_mfma_f32_16x16x32_bf16 v[64:67], v[144:147], v[180:183], v[64:67]
    ds_read_b64_tr_b16 v[136:137], v12 offset:8192
    ds_read_b64_tr_b16 v[138:139], v12 offset:9216
    v_mfma_f32_16x16x32_bf16 v[68:71], v[144:147], v[184:187], v[68:71]
    ds_read_b64_tr_b16 v[140:141], v13 offset:8192
    ds_read_b64_tr_b16 v[142:143], v13 offset:9216
    v_mfma_f32_16x16x32_bf16 v[72:75], v[144:147], v[188:191], v[72:75]
    ds_read_b128 v[168:171], v10 offset:49152
    ds_read_b128 v[172:175], v10 offset:51200
    v_mfma_f32_16x16x32_bf16 v[84:87], v[148:151], v[188:191], v[84:87]
    ds_read_b64_tr_b16 v[144:145], v14 offset:8192
    v_mfma_f32_16x16x32_bf16 v[80:83], v[148:151], v[184:187], v[80:83]
    ds_read_b64_tr_b16 v[146:147], v14 offset:9216
    v_mfma_f32_16x16x32_bf16 v[76:79], v[148:151], v[180:183], v[76:79]
    ds_read_b128 v[176:179], v10 offset:53248
    v_mfma_f32_16x16x32_bf16 v[88:91], v[152:155], v[180:183], v[88:91]
    ds_read_b64_tr_b16 v[148:149], v15 offset:8192
    v_mfma_f32_16x16x32_bf16 v[92:95], v[152:155], v[184:187], v[92:95]
    ds_read_b64_tr_b16 v[150:151], v15 offset:9216
    v_mfma_f32_16x16x32_bf16 v[96:99], v[152:155], v[188:191], v[96:99]
    ds_read_b128 v[192:195], v11 offset:49152
    v_mfma_f32_16x16x32_bf16 v[108:111], v[156:159], v[188:191], v[108:111]
    ds_read_b64_tr_b16 v[152:153], v16 offset:8192
    v_mfma_f32_16x16x32_bf16 v[104:107], v[156:159], v[184:187], v[104:107]
    ds_read_b64_tr_b16 v[154:155], v16 offset:9216
    v_mfma_f32_16x16x32_bf16 v[100:103], v[156:159], v[180:183], v[100:103]
    ds_read_b128 v[196:199], v11 offset:51200
    v_mfma_f32_16x16x32_bf16 v[112:115], v[160:163], v[180:183], v[112:115]
    ds_read_b64_tr_b16 v[156:157], v17 offset:8192
    v_mfma_f32_16x16x32_bf16 v[116:119], v[160:163], v[184:187], v[116:119]
    ds_read_b64_tr_b16 v[158:159], v17 offset:9216
    v_mfma_f32_16x16x32_bf16 v[120:123], v[160:163], v[188:191], v[120:123]
    ds_read_b128 v[200:203], v11 offset:53248
    v_mfma_f32_16x16x32_bf16 v[132:135], v[164:167], v[188:191], v[132:135]
    ds_read_b64_tr_b16 v[160:161], v18 offset:8192
    v_mfma_f32_16x16x32_bf16 v[128:131], v[164:167], v[184:187], v[128:131]
    ds_read_b64_tr_b16 v[162:163], v18 offset:9216
    v_mfma_f32_16x16x32_bf16 v[124:127], v[164:167], v[180:183], v[124:127]
    s_waitcnt lgkmcnt(15)
    v_mfma_f32_16x16x32_bf16 v[40:43], v[136:139], v[168:171], v[40:43]
    ds_read_b64_tr_b16 v[164:165], v19 offset:8192
    s_waitcnt lgkmcnt(15)
    v_mfma_f32_16x16x32_bf16 v[44:47], v[136:139], v[172:175], v[44:47]
    ds_read_b64_tr_b16 v[166:167], v19 offset:9216
    s_waitcnt lgkmcnt(13)
    v_mfma_f32_16x16x32_bf16 v[48:51], v[136:139], v[176:179], v[48:51]
    v_mfma_f32_16x16x32_bf16 v[60:63], v[140:143], v[176:179], v[60:63]
    v_mfma_f32_16x16x32_bf16 v[56:59], v[140:143], v[172:175], v[56:59]
    v_mfma_f32_16x16x32_bf16 v[52:55], v[140:143], v[168:171], v[52:55]
    s_waitcnt lgkmcnt(0)
    s_barrier
    v_mfma_f32_16x16x32_bf16 v[64:67], v[144:147], v[168:171], v[64:67]
    ds_read_b64_tr_b16 v[136:137], v12 offset:16384
    ds_read_b64_tr_b16 v[138:139], v12 offset:17408
    v_mfma_f32_16x16x32_bf16 v[68:71], v[144:147], v[172:175], v[68:71]
    ds_read_b64_tr_b16 v[140:141], v13 offset:16384
    ds_read_b64_tr_b16 v[142:143], v13 offset:17408
    v_mfma_f32_16x16x32_bf16 v[72:75], v[144:147], v[176:179], v[72:75]
    v_mfma_f32_16x16x32_bf16 v[84:87], v[148:151], v[176:179], v[84:87]
    ds_read_b64_tr_b16 v[144:145], v14 offset:16384
    v_mfma_f32_16x16x32_bf16 v[80:83], v[148:151], v[172:175], v[80:83]
    ds_read_b64_tr_b16 v[146:147], v14 offset:17408
    v_mfma_f32_16x16x32_bf16 v[76:79], v[148:151], v[168:171], v[76:79]
    v_mfma_f32_16x16x32_bf16 v[88:91], v[152:155], v[168:171], v[88:91]
    ds_read_b64_tr_b16 v[148:149], v15 offset:16384
    v_mfma_f32_16x16x32_bf16 v[92:95], v[152:155], v[172:175], v[92:95]
    ds_read_b64_tr_b16 v[150:151], v15 offset:17408
    v_mfma_f32_16x16x32_bf16 v[96:99], v[152:155], v[176:179], v[96:99]
    v_mfma_f32_16x16x32_bf16 v[108:111], v[156:159], v[176:179], v[108:111]
    ds_read_b64_tr_b16 v[152:153], v16 offset:16384
    v_mfma_f32_16x16x32_bf16 v[104:107], v[156:159], v[172:175], v[104:107]
    ds_read_b64_tr_b16 v[154:155], v16 offset:17408
    v_mfma_f32_16x16x32_bf16 v[100:103], v[156:159], v[168:171], v[100:103]
    v_mfma_f32_16x16x32_bf16 v[112:115], v[160:163], v[168:171], v[112:115]
    ds_read_b64_tr_b16 v[156:157], v17 offset:16384
    v_mfma_f32_16x16x32_bf16 v[116:119], v[160:163], v[172:175], v[116:119]
    ds_read_b64_tr_b16 v[158:159], v17 offset:17408
    v_mfma_f32_16x16x32_bf16 v[120:123], v[160:163], v[176:179], v[120:123]
    v_mfma_f32_16x16x32_bf16 v[132:135], v[164:167], v[176:179], v[132:135]
    ds_read_b64_tr_b16 v[160:161], v18 offset:16384
    v_mfma_f32_16x16x32_bf16 v[128:131], v[164:167], v[172:175], v[128:131]
    ds_read_b64_tr_b16 v[162:163], v18 offset:17408
    v_mfma_f32_16x16x32_bf16 v[124:127], v[164:167], v[168:171], v[124:127]
    s_waitcnt lgkmcnt(12)
    v_mfma_f32_16x16x32_bf16 v[40:43], v[136:139], v[192:195], v[40:43]
    ds_read_b64_tr_b16 v[164:165], v19 offset:16384
    v_mfma_f32_16x16x32_bf16 v[44:47], v[136:139], v[196:199], v[44:47]
    ds_read_b64_tr_b16 v[166:167], v19 offset:17408
    v_mfma_f32_16x16x32_bf16 v[48:51], v[136:139], v[200:203], v[48:51]
    s_waitcnt lgkmcnt(12)
    v_mfma_f32_16x16x32_bf16 v[60:63], v[140:143], v[200:203], v[60:63]
    v_mfma_f32_16x16x32_bf16 v[56:59], v[140:143], v[196:199], v[56:59]
    v_mfma_f32_16x16x32_bf16 v[52:55], v[140:143], v[192:195], v[52:55]
    s_waitcnt lgkmcnt(0)
    s_barrier
    v_mfma_f32_16x16x32_bf16 v[64:67], v[144:147], v[192:195], v[64:67]
    ds_read_b64_tr_b16 v[136:137], v12 offset:24576
    ds_read_b64_tr_b16 v[138:139], v12 offset:25600
    v_mfma_f32_16x16x32_bf16 v[68:71], v[144:147], v[196:199], v[68:71]
    ds_read_b64_tr_b16 v[140:141], v13 offset:24576
    ds_read_b64_tr_b16 v[142:143], v13 offset:25600
    v_mfma_f32_16x16x32_bf16 v[72:75], v[144:147], v[200:203], v[72:75]
    ds_read_b128 v[168:171], v10
    ds_read_b128 v[172:175], v10 offset:2048
    v_mfma_f32_16x16x32_bf16 v[84:87], v[148:151], v[200:203], v[84:87]
    ds_read_b64_tr_b16 v[144:145], v14 offset:24576
    v_mfma_f32_16x16x32_bf16 v[80:83], v[148:151], v[196:199], v[80:83]
    ds_read_b64_tr_b16 v[146:147], v14 offset:25600
    v_mfma_f32_16x16x32_bf16 v[76:79], v[148:151], v[192:195], v[76:79]
    ds_read_b128 v[176:179], v10 offset:4096
    v_mfma_f32_16x16x32_bf16 v[88:91], v[152:155], v[192:195], v[88:91]
    ds_read_b64_tr_b16 v[148:149], v15 offset:24576
    v_mfma_f32_16x16x32_bf16 v[92:95], v[152:155], v[196:199], v[92:95]
    ds_read_b64_tr_b16 v[150:151], v15 offset:25600
    v_mfma_f32_16x16x32_bf16 v[96:99], v[152:155], v[200:203], v[96:99]
    ds_read_b128 v[180:183], v11
    v_mfma_f32_16x16x32_bf16 v[108:111], v[156:159], v[200:203], v[108:111]
    ds_read_b64_tr_b16 v[152:153], v16 offset:24576
    v_mfma_f32_16x16x32_bf16 v[104:107], v[156:159], v[196:199], v[104:107]
    ds_read_b64_tr_b16 v[154:155], v16 offset:25600
    v_mfma_f32_16x16x32_bf16 v[100:103], v[156:159], v[192:195], v[100:103]
    ds_read_b128 v[184:187], v11 offset:2048
    v_mfma_f32_16x16x32_bf16 v[112:115], v[160:163], v[192:195], v[112:115]
    ds_read_b64_tr_b16 v[156:157], v17 offset:24576
    v_mfma_f32_16x16x32_bf16 v[116:119], v[160:163], v[196:199], v[116:119]
    ds_read_b64_tr_b16 v[158:159], v17 offset:25600
    v_mfma_f32_16x16x32_bf16 v[120:123], v[160:163], v[200:203], v[120:123]
    ds_read_b128 v[188:191], v11 offset:4096
    v_mfma_f32_16x16x32_bf16 v[132:135], v[164:167], v[200:203], v[132:135]
    ds_read_b64_tr_b16 v[160:161], v18 offset:24576
    v_mfma_f32_16x16x32_bf16 v[128:131], v[164:167], v[196:199], v[128:131]
    ds_read_b64_tr_b16 v[162:163], v18 offset:25600
    v_mfma_f32_16x16x32_bf16 v[124:127], v[164:167], v[192:195], v[124:127]
    s_waitcnt lgkmcnt(15)
    v_mfma_f32_16x16x32_bf16 v[40:43], v[136:139], v[168:171], v[40:43]
    ds_read_b64_tr_b16 v[164:165], v19 offset:24576
    s_waitcnt lgkmcnt(15)
    v_mfma_f32_16x16x32_bf16 v[44:47], v[136:139], v[172:175], v[44:47]
    ds_read_b64_tr_b16 v[166:167], v19 offset:25600
    s_waitcnt lgkmcnt(13)
    v_mfma_f32_16x16x32_bf16 v[48:51], v[136:139], v[176:179], v[48:51]
    v_mfma_f32_16x16x32_bf16 v[60:63], v[140:143], v[176:179], v[60:63]
    v_mfma_f32_16x16x32_bf16 v[56:59], v[140:143], v[172:175], v[56:59]
L_walk3:
L_pad3:
    s_cbranch_execz L_pad7
    v_mfma_f32_16x16x32_bf16 v[52:55], v[140:143], v[168:171], v[52:55]
    s_waitcnt lgkmcnt(0)
    s_barrier
    v_mfma_f32_16x16x32_bf16 v[64:67], v[144:147], v[168:171], v[64:67]
    ds_read_b64_tr_b16 v[136:137], v12 offset:32768
    ds_read_b64_tr_b16 v[138:139], v12 offset:33792
    v_mfma_f32_16x16x32_bf16 v[68:71], v[144:147], v[172:175], v[68:71]
    ds_read_b64_tr_b16 v[140:141], v13 offset:32768
    ds_read_b64_tr_b16 v[142:143], v13 offset:33792
    v_mfma_f32_16x16x32_bf16 v[72:75], v[144:147], v[176:179], v[72:75]
    v_mfma_f32_16x16x32_bf16 v[84:87], v[148:151], v[176:179], v[84:87]
    ds_read_b64_tr_b16 v[144:145], v14 offset:32768
    v_mfma_f32_16x16x32_bf16 v[80:83], v[148:151], v[172:175], v[80:83]
    ds_read_b64_tr_b16 v[146:147], v14 offset:33792
    v_mfma_f32_16x16x32_bf16 v[76:79], v[148:151], v[168:171], v[76:79]
    v_mfma_f32_16x16x32_bf16 v[88:91], v[152:155], v[168:171], v[88:91]
    ds_read_b64_tr_b16 v[148:149], v15 offset:32768
    v_mfma_f32_16x16x32_bf16 v[92:95], v[152:155], v[172:175], v[92:95]
    ds_read_b64_tr_b16 v[150:151], v15 offset:33792
    v_mfma_f32_16x16x32_bf16 v[96:99], v[152:155], v[176:179], v[96:99]
    v_mfma_f32_16x16x32_bf16 v[108:111], v[156:159], v[176:179], v[108:111]
    ds_read_b64_tr_b16 v[152:153], v16 offset:32768
    v_mfma_f32_16x16x32_bf16 v[104:107], v[156:159], v[172:175], v[104:107]
    ds_read_b64_tr_b16 v[154:155], v16 offset:33792
    v_mfma_f32_16x16x32_bf16 v[100:103], v[156:159], v[168:171], v[100:103]
    v_mfma_f32_16x16x32_bf16 v[112:115], v[160:163], v[168:171], v[112:115]
    ds_read_b64_tr_b16 v[156:157], v17 offset:32768
    v_mfma_f32_16x16x32_bf16 v[116:119], v[160:163], v[172:175], v[116:119]
    ds_read_b64_tr_b16 v[158:159], v17 offset:33792
    v_mfma_f32_16x16x32_bf16 v[120:123], v[160:163], v[176:179], v[120:123]
    v_mfma_f32_16x16x32_bf16 v[132:135], v[164:167], v[176:179], v[132:135]
    ds_read_b64_tr_b16 v[160:161], v18 offset:32768
    v_mfma_f32_16x16x32_bf16 v[128:131], v[164:167], v[172:175], v[128:131]
    ds_read_b64_tr_b16 v[162:163], v18 offset:33792
    v_mfma_f32_16x16x32_bf16 v[124:127], v[164:167], v[168:171], v[124:127]
    s_waitcnt lgkmcnt(12)
    v_mfma_f32_16x16x32_bf16 v[40:43], v[136:139], v[180:183], v[40:43]
    ds_read_b64_tr_b16 v[164:165], v19 offset:32768
    v_mfma_f32_16x16x32_bf16 v[44:47], v[136:139], v[184:187], v[44:47]
    ds_read_b64_tr_b16 v[166:167], v19 offset:33792
    v_mfma_f32_16x16x32_bf16 v[48:51], v[136:139], v[188:191], v[48:51]
    s_waitcnt lgkmcnt(12)
    v_mfma_f32_16x16x32_bf16 v[60:63], v[140:143], v[188:191], v[60:63]
    v_mfma_f32_16x16x32_bf16 v[56:59], v[140:143], v[184:187], v[56:59]
    v_mfma_f32_16x16x32_bf16 v[52:55], v[140:143], v[180:183], v[52:55]
    s_waitcnt lgkmcnt(0)
    s_barrier
    v_mfma_f32_16x16x32_bf16 v[64:67], v[144:147], v[180:183], v[64:67]
    ds_read_b64_tr_b16 v[136:137], v12
    ds_read_b64_tr_b16 v[138:139], v12 offset:1024
    v_mfma_f32_16x16x32_bf16 v[68:71], v[144:147], v[184:187], v[68:71]
    ds_read_b64_tr_b16 v[140:141], v13
    ds_read_b64_tr_b16 v[142:143], v13 offset:1024
    v_mfma_f32_16x16x32_bf16 v[72:75], v[144:147], v[188:191], v[72:75]
    ds_read_b128 v[168:171], v10 offset:49152
    ds_read_b128 v[172:175], v10 offset:51200
    v_mfma_f32_16x16x32_bf16 v[84:87], v[148:151], v[188:191], v[84:87]
    ds_read_b64_tr_b16 v[144:145], v14
    v_mfma_f32_16x16x32_bf16 v[80:83], v[148:151], v[184:187], v[80:83]
    ds_read_b64_tr_b16 v[146:147], v14 offset:1024
    v_mfma_f32_16x16x32_bf16 v[76:79], v[148:151], v[180:183], v[76:79]
    ds_read_b128 v[176:179], v10 offset:53248
    v_mfma_f32_16x16x32_bf16 v[88:91], v[152:155], v[180:183], v[88:91]
    ds_read_b64_tr_b16 v[148:149], v15
    v_mfma_f32_16x16x32_bf16 v[92:95], v[152:155], v[184:187], v[92:95]
    ds_read_b64_tr_b16 v[150:151], v15 offset:1024
    v_mfma_f32_16x16x32_bf16 v[96:99], v[152:155], v[188:191], v[96:99]
    ds_read_b128 v[192:195], v11 offset:49152
    v_mfma_f32_16x16x32_bf16 v[108:111], v[156:159], v[188:191], v[108:111]
    ds_read_b64_tr_b16 v[152:153], v16
    v_mfma_f32_16x16x32_bf16 v[104:107], v[156:159], v[184:187], v[104:107]
    ds_read_b64_tr_b16 v[154:155], v16 offset:1024
    v_mfma_f32_16x16x32_bf16 v[100:103], v[156:159], v[180:183], v[100:103]
    ds_read_b128 v[196:199], v11 offset:51200
    v_mfma_f32_16x16x32_bf16 v[112:115], v[160:163], v[180:183], v[112:115]
    ds_read_b64_tr_b16 v[156:157], v17
    v_mfma_f32_16x16x32_bf16 v[116:119], v[160:163], v[184:187], v[116:119]
    ds_read_b64_tr_b16 v[158:159], v17 offset:1024
    v_mfma_f32_16x16x32_bf16 v[120:123], v[160:163], v[188:191], v[120:123]
    ds_read_b128 v[200:203], v11 offset:53248
    v_mfma_f32_16x16x32_bf16 v[132:135], v[164:167], v[188:191], v[132:135]
    ds_read_b64_tr_b16 v[160:161], v18
    v_mfma_f32_16x16x32_bf16 v[128:131], v[164:167], v[184:187], v[128:131]
    ds_read_b64_tr_b16 v[162:163], v18 offset:1024
    v_mfma_f32_16x16x32_bf16 v[124:127], v[164:167], v[180:183], v[124:127]
    s_waitcnt lgkmcnt(15)
    v_mfma_f32_16x16x32_bf16 v[40:43], v[136:139], v[168:171], v[40:43]
    ds_read_b64_tr_b16 v[164:165], v19
    s_waitcnt lgkmcnt(15)
    v_mfma_f32_16x16x32_bf16 v[44:47], v[136:139], v[172:175], v[44:47]
    ds_read_b64_tr_b16 v[166:167], v19 offset:1024
    s_waitcnt lgkmcnt(13)
    v_mfma_f32_16x16x32_bf16 v[48:51], v[136:139], v[176:179], v[48:51]
    v_mfma_f32_16x16x32_bf16 v[60:63], v[140:143], v[176:179], v[60:63]
    v_mfma_f32_16x16x32_bf16 v[56:59], v[140:143], v[172:175], v[56:59]
    v_mfma_f32_16x16x32_bf16 v[52:55], v[140:143], v[168:171], v[52:55]
    s_waitcnt lgkmcnt(0)
    s_barrier
    v_mfma_f32_16x16x32_bf16 v[64:67], v[144:147], v[168:171], v[64:67]
    ds_read_b64_tr_b16 v[136:137], v12 offset:8192
    ds_read_b64_tr_b16 v[138:139], v12 offset:9216
    v_mfma_f32_16x16x32_bf16 v[68:71], v[144:147], v[172:175], v[68:71]
    ds_read_b64_tr_b16 v[140:141], v13 offset:8192
    ds_read_b64_tr_b16 v[142:143], v13 offset:9216
    v_mfma_f32_16x16x32_bf16 v[72:75], v[144:147], v[176:179], v[72:75]
    v_mfma_f32_16x16x32_bf16 v[84:87], v[148:151], v[176:179], v[84:87]
    ds_read_b64_tr_b16 v[144:145], v14 offset:8192
    v_mfma_f32_16x16x32_bf16 v[80:83], v[148:151], v[172:175], v[80:83]
    ds_read_b64_tr_b16 v[146:147], v14 offset:9216
    v_mfma_f32_16x16x32_bf16 v[76:79], v[148:151], v[168:171], v[76:79]
    v_mfma_f32_16x16x32_bf16 v[88:91], v[152:155], v[168:171], v[88:91]
    ds_read_b64_tr_b16 v[148:149], v15 offset:8192
    v_mfma_f32_16x16x32_bf16 v[92:95], v[152:155], v[172:175], v[92:95]
    ds_read_b64_tr_b16 v[150:151], v15 offset:9216
    v_mfma_f32_16x16x32_bf16 v[96:99], v[152:155], v[176:179], v[96:99]
    v_mfma_f32_16x16x32_bf16 v[108:111], v[156:159], v[176:179], v[108:111]
    ds_read_b64_tr_b16 v[152:153], v16 offset:8192
    v_mfma_f32_16x16x32_bf16 v[104:107], v[156:159], v[172:175], v[104:107]
    ds_read_b64_tr_b16 v[154:155], v16 offset:9216
    v_mfma_f32_16x16x32_bf16 v[100:103], v[156:159], v[168:171], v[100:103]
    v_mfma_f32_16x16x32_bf16 v[112:115], v[160:163], v[168:171], v[112:115]
    ds_read_b64_tr_b16 v[156:157], v17 offset:8192
    v_mfma_f32_16x16x32_bf16 v[116:119], v[160:163], v[172:175], v[116:119]
    ds_read_b64_tr_b16 v[158:159], v17 offset:9216
    v_mfma_f32_16x16x32_bf16 v[120:123], v[160:163], v[176:179], v[120:123]
    v_mfma_f32_16x16x32_bf16 v[132:135], v[164:167], v[176:179], v[132:135]
    ds_read_b64_tr_b16 v[160:161], v18 offset:8192
    v_mfma_f32_16x16x32_bf16 v[128:131], v[164:167], v[172:175], v[128:131]
    ds_read_b64_tr_b16 v[162:163], v18 offset:9216
    v_mfma_f32_16x16x32_bf16 v[124:127], v[164:167], v[168:171], v[124:127]
    s_waitcnt lgkmcnt(12)
    v_mfma_f32_16x16x32_bf16 v[40:43], v[136:139], v[192:195], v[40:43]
    ds_read_b64_tr_b16 v[164:165], v19 offset:8192
    v_mfma_f32_16x16x32_bf16 v[44:47], v[136:139], v[196:199], v[44:47]
    ds_read_b64_tr_b16 v[166:167], v19 offset:9216
    v_mfma_f32_16x16x32_bf16 v[48:51], v[136:139], v[200:203], v[48:51]
    s_waitcnt lgkmcnt(12)
    v_mfma_f32_16x16x32_bf16 v[60:63], v[140:143], v[200:203], v[60:63]
    v_mfma_f32_16x16x32_bf16 v[56:59], v[140:143], v[196:199], v[56:59]
    v_mfma_f32_16x16x32_bf16 v[52:55], v[140:143], v[192:195], v[52:55]
    s_waitcnt lgkmcnt(0)
    s_barrier
    v_mfma_f32_16x16x32_bf16 v[64:67], v[144:147], v[192:195], v[64:67]
    ds_read_b64_tr_b16 v[136:137], v12 offset:16384
    ds_read_b64_tr_b16 v[138:139], v12 offset:17408
    v_mfma_f32_16x16x32_bf16 v[68:71], v[144:147], v[196:199], v[68:71]
    ds_read_b64_tr_b16 v[140:141], v13 offset:16384
    ds_read_b64_tr_b16 v[142:143], v13 offset:17408
    v_mfma_f32_16x16x32_bf16 v[72:75], v[144:147], v[200:203], v[72:75]
    ds_read_b128 v[168:171], v10 offset:24576
    ds_read_b128 v[172:175], v10 offset:26624
    v_mfma_f32_16x16x32_bf16 v[84:87], v[148:151], v[200:203], v[84:87]
    ds_read_b64_tr_b16 v[144:145], v14 offset:16384
    v_mfma_f32_16x16x32_bf16 v[80:83], v[148:151], v[196:199], v[80:83]
    ds_read_b64_tr_b16 v[146:147], v14 offset:17408
    v_mfma_f32_16x16x32_bf16 v[76:79], v[148:151], v[192:195], v[76:79]
    ds_read_b128 v[176:179], v10 offset:28672
    v_mfma_f32_16x16x32_bf16 v[88:91], v[152:155], v[192:195], v[88:91]
    ds_read_b64_tr_b16 v[148:149], v15 offset:16384
    v_mfma_f32_16x16x32_bf16 v[92:95], v[152:155], v[196:199], v[92:95]
    ds_read_b64_tr_b16 v[150:151], v15 offset:17408
    v_mfma_f32_16x16x32_bf16 v[96:99], v[152:155], v[200:203], v[96:99]
    ds_read_b128 v[180:183], v11 offset:24576
    v_mfma_f32_16x16x32_bf16 v[108:111], v[156:159], v[200:203], v[108:111]
    ds_read_b64_tr_b16 v[152:153], v16 offset:16384
    v_mfma_f32_16x16x32_bf16 v[104:107], v[156:159], v[196:199], v[104:107]
    ds_read_b64_tr_b16 v[154:155], v16 offset:17408
    v_mfma_f32_16x16x32_bf16 v[100:103], v[156:159], v[192:195], v[100:103]
    ds_read_b128 v[184:187], v11 offset:26624
    v_mfma_f32_16x16x32_bf16 v[112:115], v[160:163], v[192:195], v[112:115]
    ds_read_b64_tr_b16 v[156:157], v17 offset:16384
    v_mfma_f32_16x16x32_bf16 v[116:119], v[160:163], v[196:199], v[116:119]
    ds_read_b64_tr_b16 v[158:159], v17 offset:17408
    v_mfma_f32_16x16x32_bf16 v[120:123], v[160:163], v[200:203], v[120:123]
    ds_read_b128 v[188:191], v11 offset:28672
    v_mfma_f32_16x16x32_bf16 v[132:135], v[164:167], v[200:203], v[132:135]
    ds_read_b64_tr_b16 v[160:161], v18 offset:16384
    v_mfma_f32_16x16x32_bf16 v[128:131], v[164:167], v[196:199], v[128:131]
    ds_read_b64_tr_b16 v[162:163], v18 offset:17408
    v_mfma_f32_16x16x32_bf16 v[124:127], v[164:167], v[192:195], v[124:127]
    s_waitcnt lgkmcnt(15)
    v_mfma_f32_16x16x32_bf16 v[40:43], v[136:139], v[168:171], v[40:43]
    ds_read_b64_tr_b16 v[164:165], v19 offset:16384
    s_waitcnt lgkmcnt(15)
    v_mfma_f32_16x16x32_bf16 v[44:47], v[136:139], v[172:175], v[44:47]
    ds_read_b64_tr_b16 v[166:167], v19 offset:17408
    s_waitcnt lgkmcnt(13)
    v_mfma_f32_16x16x32_bf16 v[48:51], v[136:139], v[176:179], v[48:51]
    v_mfma_f32_16x16x32_bf16 v[60:63], v[140:143], v[176:179], v[60:63]
    v_mfma_f32_16x16x32_bf16 v[56:59], v[140:143], v[172:175], v[56:59]
    v_mfma_f32_16x16x32_bf16 v[52:55], v[140:143], v[168:171], v[52:55]
    s_waitcnt lgkmcnt(0)
    s_barrier
    v_mfma_f32_16x16x32_bf16 v[64:67], v[144:147], v[168:171], v[64:67]
    ds_read_b64_tr_b16 v[136:137], v12 offset:24576
    ds_read_b64_tr_b16 v[138:139], v12 offset:25600
    v_mfma_f32_16x16x32_bf16 v[68:71], v[144:147], v[172:175], v[68:71]
    ds_read_b64_tr_b16 v[140:141], v13 offset:24576
    ds_read_b64_tr_b16 v[142:143], v13 offset:25600
    v_mfma_f32_16x16x32_bf16 v[72:75], v[144:147], v[176:179], v[72:75]
    v_mfma_f32_16x16x32_bf16 v[84:87], v[148:151], v[176:179], v[84:87]
    ds_read_b64_tr_b16 v[144:145], v14 offset:24576
    v_mfma_f32_16x16x32_bf16 v[80:83], v[148:151], v[172:175], v[80:83]
    ds_read_b64_tr_b16 v[146:147], v14 offset:25600
    v_mfma_f32_16x16x32_bf16 v[76:79], v[148:151], v[168:171], v[76:79]
    v_mfma_f32_16x16x32_bf16 v[88:91], v[152:155], v[168:171], v[88:91]
    ds_read_b64_tr_b16 v[148:149], v15 offset:24576
    v_mfma_f32_16x16x32_bf16 v[92:95], v[152:155], v[172:175], v[92:95]
    ds_read_b64_tr_b16 v[150:151], v15 offset:25600
    v_mfma_f32_16x16x32_bf16 v[96:99], v[152:155], v[176:179], v[96:99]
    v_mfma_f32_16x16x32_bf16 v[108:111], v[156:159], v[176:179], v[108:111]
    ds_read_b64_tr_b16 v[152:153], v16 offset:24576
    v_mfma_f32_16x16x32_bf16 v[104:107], v[156:159], v[172:175], v[104:107]
    ds_read_b64_tr_b16 v[154:155], v16 offset:25600
    v_mfma_f32_16x16x32_bf16 v[100:103], v[156:159], v[168:171], v[100:103]
    v_mfma_f32_16x16x32_bf16 v[112:115], v[160:163], v[168:171], v[112:115]
    ds_read_b64_tr_b16 v[156:157], v17 offset:24576
    v_mfma_f32_16x16x32_bf16 v[116:119], v[160:163], v[172:175], v[116:119]
    ds_read_b64_tr_b16 v[158:159], v17 offset:25600
    v_mfma_f32_16x16x32_bf16 v[120:123], v[160:163], v[176:179], v[120:123]
    v_mfma_f32_16x16x32_bf16 v[132:135], v[164:167], v[176:179], v[132:135]
    ds_read_b64_tr_b16 v[160:161], v18 offset:24576
    v_mfma_f32_16x16x32_bf16 v[128:131], v[164:167], v[172:175], v[128:131]
    ds_read_b64_tr_b16 v[162:163], v18 offset:25600
    v_mfma_f32_16x16x32_bf16 v[124:127], v[164:167], v[168:171], v[124:127]
    s_waitcnt lgkmcnt(12)
    v_mfma_f32_16x16x32_bf16 v[40:43], v[136:139], v[180:183], v[40:43]
    ds_read_b64_tr_b16 v[164:165], v19 offset:24576
    v_mfma_f32_16x16x32_bf16 v[44:47], v[136:139], v[184:187], v[44:47]
    ds_read_b64_tr_b16 v[166:167], v19 offset:25600
    v_mfma_f32_16x16x32_bf16 v[48:51], v[136:139], v[188:191], v[48:51]
    s_waitcnt lgkmcnt(12)
    v_mfma_f32_16x16x32_bf16 v[60:63], v[140:143], v[188:191], v[60:63]
    v_mfma_f32_16x16x32_bf16 v[56:59], v[140:143], v[184:187], v[56:59]
    v_mfma_f32_16x16x32_bf16 v[52:55], v[140:143], v[180:183], v[52:55]
    s_waitcnt lgkmcnt(0)
    s_barrier
    v_mfma_f32_16x16x32_bf16 v[64:67], v[144:147], v[180:183], v[64:67]
    ds_read_b64_tr_b16 v[136:137], v12 offset:32768
    ds_read_b64_tr_b16 v[138:139], v12 offset:33792
    v_mfma_f32_16x16x32_bf16 v[68:71], v[144:147], v[184:187], v[68:71]
    ds_read_b64_tr_b16 v[140:141], v13 offset:32768
    ds_read_b64_tr_b16 v[142:143], v13 offset:33792
    v_mfma_f32_16x16x32_bf16 v[72:75], v[144:147], v[188:191], v[72:75]
    ds_read_b128 v[168:171], v10 offset:49152
    ds_read_b128 v[172:175], v10 offset:51200
    v_mfma_f32_16x16x32_bf16 v[84:87], v[148:151], v[188:191], v[84:87]
    ds_read_b64_tr_b16 v[144:145], v14 offset:32768
    v_mfma_f32_16x16x32_bf16 v[80:83], v[148:151], v[184:187], v[80:83]
    ds_read_b64_tr_b16 v[146:147], v14 offset:33792
    v_mfma_f32_16x16x32_bf16 v[76:79], v[148:151], v[180:183], v[76:79]
    ds_read_b128 v[176:179], v10 offset:53248
    v_mfma_f32_16x16x32_bf16 v[88:91], v[152:155], v[180:183], v[88:91]
    ds_read_b64_tr_b16 v[148:149], v15 offset:32768
    v_mfma_f32_16x16x32_bf16 v[92:95], v[152:155], v[184:187], v[92:95]
    ds_read_b64_tr_b16 v[150:151], v15 offset:33792
    v_mfma_f32_16x16x32_bf16 v[96:99], v[152:155], v[188:191], v[96:99]
    ds_read_b128 v[192:195], v11 offset:49152
    v_mfma_f32_16x16x32_bf16 v[108:111], v[156:159], v[188:191], v[108:111]
    ds_read_b64_tr_b16 v[152:153], v16 offset:32768
    v_mfma_f32_16x16x32_bf16 v[104:107], v[156:159], v[184:187], v[104:107]
    ds_read_b64_tr_b16 v[154:155], v16 offset:33792
    v_mfma_f32_16x16x32_bf16 v[100:103], v[156:159], v[180:183], v[100:103]
    ds_read_b128 v[196:199], v11 offset:51200
    v_mfma_f32_16x16x32_bf16 v[112:115], v[160:163], v[180:183], v[112:115]
    ds_read_b64_tr_b16 v[156:157], v17 offset:32768
    v_mfma_f32_16x16x32_bf16 v[116:119], v[160:163], v[184:187], v[116:119]
    ds_read_b64_tr_b16 v[158:159], v17 offset:33792
    v_mfma_f32_16x16x32_bf16 v[120:123], v[160:163], v[188:191], v[120:123]
    ds_read_b128 v[200:203], v11 offset:53248
    v_mfma_f32_16x16x32_bf16 v[132:135], v[164:167], v[188:191], v[132:135]
    ds_read_b64_tr_b16 v[160:161], v18 offset:32768
    v_mfma_f32_16x16x32_bf16 v[128:131], v[164:167], v[184:187], v[128:131]
    ds_read_b64_tr_b16 v[162:163], v18 offset:33792
    v_mfma_f32_16x16x32_bf16 v[124:127], v[164:167], v[180:183], v[124:127]
    s_waitcnt lgkmcnt(15)
    v_mfma_f32_16x16x32_bf16 v[40:43], v[136:139], v[168:171], v[40:43]
    ds_read_b64_tr_b16 v[164:165], v19 offset:32768
    s_waitcnt lgkmcnt(15)
    v_mfma_f32_16x16x32_bf16 v[44:47], v[136:139], v[172:175], v[44:47]
    ds_read_b64_tr_b16 v[166:167], v19 offset:33792
    s_waitcnt lgkmcnt(13)
    v_mfma_f32_16x16x32_bf16 v[48:51], v[136:139], v[176:179], v[48:51]
    v_mfma_f32_16x16x32_bf16 v[60:63], v[140:143], v[176:179], v[60:63]
    v_mfma_f32_16x16x32_bf16 v[56:59], v[140:143], v[172:175], v[56:59]
    v_mfma_f32_16x16x32_bf16 v[52:55], v[140:143], v[168:171], v[52:55]
    s_waitcnt lgkmcnt(0)
    s_barrier
    v_mfma_f32_16x16x32_bf16 v[64:67], v[144:147], v[168:171], v[64:67]
    ds_read_b64_tr_b16 v[136:137], v12
    ds_read_b64_tr_b16 v[138:139], v12 offset:1024
    v_mfma_f32_16x16x32_bf16 v[68:71], v[144:147], v[172:175], v[68:71]
    ds_read_b64_tr_b16 v[140:141], v13
    ds_read_b64_tr_b16 v[142:143], v13 offset:1024
    v_mfma_f32_16x16x32_bf16 v[72:75], v[144:147], v[176:179], v[72:75]
    v_mfma_f32_16x16x32_bf16 v[84:87], v[148:151], v[176:179], v[84:87]
    ds_read_b64_tr_b16 v[144:145], v14
    v_mfma_f32_16x16x32_bf16 v[80:83], v[148:151], v[172:175], v[80:83]
    ds_read_b64_tr_b16 v[146:147], v14 offset:1024
    v_mfma_f32_16x16x32_bf16 v[76:79], v[148:151], v[168:171], v[76:79]
    v_mfma_f32_16x16x32_bf16 v[88:91], v[152:155], v[168:171], v[88:91]
    ds_read_b64_tr_b16 v[148:149], v15
    v_mfma_f32_16x16x32_bf16 v[92:95], v[152:155], v[172:175], v[92:95]
    ds_read_b64_tr_b16 v[150:151], v15 offset:1024
    v_mfma_f32_16x16x32_bf16 v[96:99], v[152:155], v[176:179], v[96:99]
    v_mfma_f32_16x16x32_bf16 v[108:111], v[156:159], v[176:179], v[108:111]
    ds_read_b64_tr_b16 v[152:153], v16
    v_mfma_f32_16x16x32_bf16 v[104:107], v[156:159], v[172:175], v[104:107]
    ds_read_b64_tr_b16 v[154:155], v16 offset:1024
    v_mfma_f32_16x16x32_bf16 v[100:103], v[156:159], v[168:171], v[100:103]
    v_mfma_f32_16x16x32_bf16 v[112:115], v[160:163], v[168:171], v[112:115]
    ds_read_b64_tr_b16 v[156:157], v17
    v_mfma_f32_16x16x32_bf16 v[116:119], v[160:163], v[172:175], v[116:119]
    ds_read_b64_tr_b16 v[158:159], v17 offset:1024
    v_mfma_f32_16x16x32_bf16 v[120:123], v[160:163], v[176:179], v[120:123]
    v_mfma_f32_16x16x32_bf16 v[132:135], v[164:167], v[176:179], v[132:135]
    ds_read_b64_tr_b16 v[160:161], v18
    v_mfma_f32_16x16x32_bf16 v[128:131], v[164:167], v[172:175], v[128:131]
    ds_read_b64_tr_b16 v[162:163], v18 offset:1024
    v_mfma_f32_16x16x32_bf16 v[124:127], v[164:167], v[168:171], v[124:127]
    s_waitcnt lgkmcnt(12)
    v_mfma_f32_16x16x32_bf16 v[40:43], v[136:139], v[192:195], v[40:43]
    ds_read_b64_tr_b16 v[164:165], v19
    v_mfma_f32_16x16x32_bf16 v[44:47], v[136:139], v[196:199], v[44:47]
    ds_read_b64_tr_b16 v[166:167], v19 offset:1024
    v_mfma_f32_16x16x32_bf16 v[48:51], v[136:139], v[200:203], v[48:51]
    s_waitcnt lgkmcnt(12)
    v_mfma_f32_16x16x32_bf16 v[60:63], v[140:143], v[200:203], v[60:63]
    v_mfma_f32_16x16x32_bf16 v[56:59], v[140:143], v[196:199], v[56:59]
    v_mfma_f32_16x16x32_bf16 v[52:55], v[140:143], v[192:195], v[52:55]
    s_waitcnt lgkmcnt(0)
    s_barrier
    v_mfma_f32_16x16x32_bf16 v[64:67], v[144:147], v[192:195], v[64:67]
    ds_read_b64_tr_b16 v[136:137], v12 offset:8192
    ds_read_b64_tr_b16 v[138:139], v12 offset:9216
    v_mfma_f32_16x16x32_bf16 v[68:71], v[144:147], v[196:199], v[68:71]
    ds_read_b64_tr_b16 v[140:141], v13 offset:8192
    ds_read_b64_tr_b16 v[142:143], v13 offset:9216
    v_mfma_f32_16x16x32_bf16 v[72:75], v[144:147], v[200:203], v[72:75]
    ds_read_b128 v[168:171], v10 offset:24576
    ds_read_b128 v[172:175], v10 offset:26624
    v_mfma_f32_16x16x32_bf16 v[84:87], v[148:151], v[200:203], v[84:87]
    ds_read_b64_tr_b16 v[144:145], v14 offset:8192
    v_mfma_f32_16x16x32_bf16 v[80:83], v[148:151], v[196:199], v[80:83]
    ds_read_b64_tr_b16 v[146:147], v14 offset:9216
    v_mfma_f32_16x16x32_bf16 v[76:79], v[148:151], v[192:195], v[76:79]
    ds_read_b128 v[176:179], v10 offset:28672
    v_mfma_f32_16x16x32_bf16 v[88:91], v[152:155], v[192:195], v[88:91]
    ds_read_b64_tr_b16 v[148:149], v15 offset:8192
    v_mfma_f32_16x16x32_bf16 v[92:95], v[152:155], v[196:199], v[92:95]
    ds_read_b64_tr_b16 v[150:151], v15 offset:9216
    v_mfma_f32_16x16x32_bf16 v[96:99], v[152:155], v[200:203], v[96:99]
    ds_read_b128 v[180:183], v11 offset:24576
    v_mfma_f32_16x16x32_bf16 v[108:111], v[156:159], v[200:203], v[108:111]
    ds_read_b64_tr_b16 v[152:153], v16 offset:8192
    v_mfma_f32_16x16x32_bf16 v[104:107], v[156:159], v[196:199], v[104:107]
    ds_read_b64_tr_b16 v[154:155], v16 offset:9216
    v_mfma_f32_16x16x32_bf16 v[100:103], v[156:159], v[192:195], v[100:103]
    ds_read_b128 v[184:187], v11 offset:26624
    v_mfma_f32_16x16x32_bf16 v[112:115], v[160:163], v[192:195], v[112:115]
    ds_read_b64_tr_b16 v[156:157], v17 offset:8192
    v_mfma_f32_16x16x32_bf16 v[116:119], v[160:163], v[196:199], v[116:119]
    ds_read_b64_tr_b16 v[158:159], v17 offset:9216
    v_mfma_f32_16x16x32_bf16 v[120:123], v[160:163], v[200:203], v[120:123]
    ds_read_b128 v[188:191], v11 offset:28672
    v_mfma_f32_16x16x32_bf16 v[132:135], v[164:167], v[200:203], v[132:135]
    ds_read_b64_tr_b16 v[160:161], v18 offset:8192
    v_mfma_f32_16x16x32_bf16 v[128:131], v[164:167], v[196:199], v[128:131]
    ds_read_b64_tr_b16 v[162:163], v18 offset:9216
    v_mfma_f32_16x16x32_bf16 v[124:127], v[164:167], v[192:195], v[124:127]
    s_waitcnt lgkmcnt(15)
    v_mfma_f32_16x16x32_bf16 v[40:43], v[136:139], v[168:171], v[40:43]
    ds_read_b64_tr_b16 v[164:165], v19 offset:8192
    s_waitcnt lgkmcnt(15)
    v_mfma_f32_16x16x32_bf16 v[44:47], v[136:139], v[172:175], v[44:47]
    ds_read_b64_tr_b16 v[166:167], v19 offset:9216
    s_waitcnt lgkmcnt(13)
    v_mfma_f32_16x16x32_bf16 v[48:51], v[136:139], v[176:179], v[48:51]
    v_mfma_f32_16x16x32_bf16 v[60:63], v[140:143], v[176:179], v[60:63]
    v_mfma_f32_16x16x32_bf16 v[56:59], v[140:143], v[172:175], v[56:59]
    v_mfma_f32_16x16x32_bf16 v[52:55], v[140:143], v[168:171], v[52:55]
    s_waitcnt lgkmcnt(0)
    s_barrier
    v_mfma_f32_16x16x32_bf16 v[64:67], v[144:147], v[168:171], v[64:67]
    ds_read_b64_tr_b16 v[136:137], v12 offset:16384
    ds_read_b64_tr_b16 v[138:139], v12 offset:17408
    v_mfma_f32_16x16x32_bf16 v[68:71], v[144:147], v[172:175], v[68:71]
    ds_read_b64_tr_b16 v[140:141], v13 offset:16384
    ds_read_b64_tr_b16 v[142:143], v13 offset:17408
    v_mfma_f32_16x16x32_bf16 v[72:75], v[144:147], v[176:179], v[72:75]
    v_mfma_f32_16x16x32_bf16 v[84:87], v[148:151], v[176:179], v[84:87]
    ds_read_b64_tr_b16 v[144:145], v14 offset:16384
    v_mfma_f32_16x16x32_bf16 v[80:83], v[148:151], v[172:175], v[80:83]
    ds_read_b64_tr_b16 v[146:147], v14 offset:17408
    v_mfma_f32_16x16x32_bf16 v[76:79], v[148:151], v[168:171], v[76:79]
    v_mfma_f32_16x16x32_bf16 v[88:91], v[152:155], v[168:171], v[88:91]
    ds_read_b64_tr_b16 v[148:149], v15 offset:16384
    v_mfma_f32_16x16x32_bf16 v[92:95], v[152:155], v[172:175], v[92:95]
    ds_read_b64_tr_b16 v[150:151], v15 offset:17408
    v_mfma_f32_16x16x32_bf16 v[96:99], v[152:155], v[176:179], v[96:99]
    v_mfma_f32_16x16x32_bf16 v[108:111], v[156:159], v[176:179], v[108:111]
    ds_read_b64_tr_b16 v[152:153], v16 offset:16384
    v_mfma_f32_16x16x32_bf16 v[104:107], v[156:159], v[172:175], v[104:107]
    ds_read_b64_tr_b16 v[154:155], v16 offset:17408
    v_mfma_f32_16x16x32_bf16 v[100:103], v[156:159], v[168:171], v[100:103]
    v_mfma_f32_16x16x32_bf16 v[112:115], v[160:163], v[168:171], v[112:115]
    ds_read_b64_tr_b16 v[156:157], v17 offset:16384
    v_mfma_f32_16x16x32_bf16 v[116:119], v[160:163], v[172:175], v[116:119]
    ds_read_b64_tr_b16 v[158:159], v17 offset:17408
    v_mfma_f32_16x16x32_bf16 v[120:123], v[160:163], v[176:179], v[120:123]
    v_mfma_f32_16x16x32_bf16 v[132:135], v[164:167], v[176:179], v[132:135]
    ds_read_b64_tr_b16 v[160:161], v18 offset:16384
    v_mfma_f32_16x16x32_bf16 v[128:131], v[164:167], v[172:175], v[128:131]
    ds_read_b64_tr_b16 v[162:163], v18 offset:17408
    v_mfma_f32_16x16x32_bf16 v[124:127], v[164:167], v[168:171], v[124:127]
    s_waitcnt lgkmcnt(12)
    v_mfma_f32_16x16x32_bf16 v[40:43], v[136:139], v[180:183], v[40:43]
    ds_read_b64_tr_b16 v[164:165], v19 offset:16384
    v_mfma_f32_16x16x32_bf16 v[44:47], v[136:139], v[184:187], v[44:47]
    ds_read_b64_tr_b16 v[166:167], v19 offset:17408
    v_mfma_f32_16x16x32_bf16 v[48:51], v[136:139], v[188:191], v[48:51]
    s_waitcnt lgkmcnt(12)
    v_mfma_f32_16x16x32_bf16 v[60:63], v[140:143], v[188:191], v[60:63]
    v_mfma_f32_16x16x32_bf16 v[56:59], v[140:143], v[184:187], v[56:59]
    v_mfma_f32_16x16x32_bf16 v[52:55], v[140:143], v[180:183], v[52:55]
    s_waitcnt lgkmcnt(0)
    s_barrier
    v_mfma_f32_16x16x32_bf16 v[64:67], v[144:147], v[180:183], v[64:67]
    ds_read_b64_tr_b16 v[136:137], v12 offset:24576
    ds_read_b64_tr_b16 v[138:139], v12 offset:25600
    v_mfma_f32_16x16x32_bf16 v[68:71], v[144:147], v[184:187], v[68:71]
    ds_read_b64_tr_b16 v[140:141], v13 offset:24576
    ds_read_b64_tr_b16 v[142:143], v13 offset:25600
    v_mfma_f32_16x16x32_bf16 v[72:75], v[144:147], v[188:191], v[72:75]
    ds_read_b128 v[168:171], v10 offset:49152
    ds_read_b128 v[172:175], v10 offset:51200
    v_mfma_f32_16x16x32_bf16 v[84:87], v[148:151], v[188:191], v[84:87]
    ds_read_b64_tr_b16 v[144:145], v14 offset:24576
    v_mfma_f32_16x16x32_bf16 v[80:83], v[148:151], v[184:187], v[80:83]
    ds_read_b64_tr_b16 v[146:147], v14 offset:25600
    v_mfma_f32_16x16x32_bf16 v[76:79], v[148:151], v[180:183], v[76:79]
    ds_read_b128 v[176:179], v10 offset:53248
    v_mfma_f32_16x16x32_bf16 v[88:91], v[152:155], v[180:183], v[88:91]
    ds_read_b64_tr_b16 v[148:149], v15 offset:24576
    v_mfma_f32_16x16x32_bf16 v[92:95], v[152:155], v[184:187], v[92:95]
    ds_read_b64_tr_b16 v[150:151], v15 offset:25600
    v_mfma_f32_16x16x32_bf16 v[96:99], v[152:155], v[188:191], v[96:99]
    ds_read_b128 v[192:195], v11 offset:49152
    v_mfma_f32_16x16x32_bf16 v[108:111], v[156:159], v[188:191], v[108:111]
    ds_read_b64_tr_b16 v[152:153], v16 offset:24576
    v_mfma_f32_16x16x32_bf16 v[104:107], v[156:159], v[184:187], v[104:107]
    ds_read_b64_tr_b16 v[154:155], v16 offset:25600
    v_mfma_f32_16x16x32_bf16 v[100:103], v[156:159], v[180:183], v[100:103]
    ds_read_b128 v[196:199], v11 offset:51200
    v_mfma_f32_16x16x32_bf16 v[112:115], v[160:163], v[180:183], v[112:115]
    ds_read_b64_tr_b16 v[156:157], v17 offset:24576
    v_mfma_f32_16x16x32_bf16 v[116:119], v[160:163], v[184:187], v[116:119]
    ds_read_b64_tr_b16 v[158:159], v17 offset:25600
    v_mfma_f32_16x16x32_bf16 v[120:123], v[160:163], v[188:191], v[120:123]
    ds_read_b128 v[200:203], v11 offset:53248
    v_mfma_f32_16x16x32_bf16 v[132:135], v[164:167], v[188:191], v[132:135]
    ds_read_b64_tr_b16 v[160:161], v18 offset:24576
    v_mfma_f32_16x16x32_bf16 v[128:131], v[164:167], v[184:187], v[128:131]
    ds_read_b64_tr_b16 v[162:163], v18 offset:25600
    v_mfma_f32_16x16x32_bf16 v[124:127], v[164:167], v[180:183], v[124:127]
    s_waitcnt lgkmcnt(15)
    v_mfma_f32_16x16x32_bf16 v[40:43], v[136:139], v[168:171], v[40:43]
    ds_read_b64_tr_b16 v[164:165], v19 offset:24576
    s_waitcnt lgkmcnt(15)
    v_mfma_f32_16x16x32_bf16 v[44:47], v[136:139], v[172:175], v[44:47]
    ds_read_b64_tr_b16 v[166:167], v19 offset:25600
    s_waitcnt lgkmcnt(13)
    v_mfma_f32_16x16x32_bf16 v[48:51], v[136:139], v[176:179], v[48:51]
    v_mfma_f32_16x16x32_bf16 v[60:63], v[140:143], v[176:179], v[60:63]
    v_mfma_f32_16x16x32_bf16 v[56:59], v[140:143], v[172:175], v[56:59]
    v_mfma_f32_16x16x32_bf16 v[52:55], v[140:143], v[168:171], v[52:55]
    s_waitcnt lgkmcnt(0)
    s_barrier
    v_mfma_f32_16x16x32_bf16 v[64:67], v[144:147], v[168:171], v[64:67]
    ds_read_b64_tr_b16 v[136:137], v12 offset:32768
    ds_read_b64_tr_b16 v[138:139], v12 offset:33792
    v_mfma_f32_16x16x32_bf16 v[68:71], v[144:147], v[172:175], v[68:71]
    ds_read_b64_tr_b16 v[140:141], v13 offset:32768
    ds_read_b64_tr_b16 v[142:143], v13 offset:33792
    v_mfma_f32_16x16x32_bf16 v[72:75], v[144:147], v[176:179], v[72:75]
    v_mfma_f32_16x16x32_bf16 v[84:87], v[148:151], v[176:179], v[84:87]
    ds_read_b64_tr_b16 v[144:145], v14 offset:32768
    v_mfma_f32_16x16x32_bf16 v[80:83], v[148:151], v[172:175], v[80:83]
    ds_read_b64_tr_b16 v[146:147], v14 offset:33792
    v_mfma_f32_16x16x32_bf16 v[76:79], v[148:151], v[168:171], v[76:79]
    v_mfma_f32_16x16x32_bf16 v[88:91], v[152:155], v[168:171], v[88:91]
    ds_read_b64_tr_b16 v[148:149], v15 offset:32768
    v_mfma_f32_16x16x32_bf16 v[92:95], v[152:155], v[172:175], v[92:95]
    ds_read_b64_tr_b16 v[150:151], v15 offset:33792
    v_mfma_f32_16x16x32_bf16 v[96:99], v[152:155], v[176:179], v[96:99]
    v_mfma_f32_16x16x32_bf16 v[108:111], v[156:159], v[176:179], v[108:111]
    ds_read_b64_tr_b16 v[152:153], v16 offset:32768
    v_mfma_f32_16x16x32_bf16 v[104:107], v[156:159], v[172:175], v[104:107]
    ds_read_b64_tr_b16 v[154:155], v16 offset:33792
    v_mfma_f32_16x16x32_bf16 v[100:103], v[156:159], v[168:171], v[100:103]
    v_mfma_f32_16x16x32_bf16 v[112:115], v[160:163], v[168:171], v[112:115]
    ds_read_b64_tr_b16 v[156:157], v17 offset:32768
    v_mfma_f32_16x16x32_bf16 v[116:119], v[160:163], v[172:175], v[116:119]
    ds_read_b64_tr_b16 v[158:159], v17 offset:33792
    v_mfma_f32_16x16x32_bf16 v[120:123], v[160:163], v[176:179], v[120:123]
    v_mfma_f32_16x16x32_bf16 v[132:135], v[164:167], v[176:179], v[132:135]
    ds_read_b64_tr_b16 v[160:161], v18 offset:32768
    v_mfma_f32_16x16x32_bf16 v[128:131], v[164:167], v[172:175], v[128:131]
    ds_read_b64_tr_b16 v[162:163], v18 offset:33792
    v_mfma_f32_16x16x32_bf16 v[124:127], v[164:167], v[168:171], v[124:127]
    s_waitcnt lgkmcnt(12)
    v_mfma_f32_16x16x32_bf16 v[40:43], v[136:139], v[192:195], v[40:43]
    ds_read_b64_tr_b16 v[164:165], v19 offset:32768
    v_mfma_f32_16x16x32_bf16 v[44:47], v[136:139], v[196:199], v[44:47]
    ds_read_b64_tr_b16 v[166:167], v19 offset:33792
    v_mfma_f32_16x16x32_bf16 v[48:51], v[136:139], v[200:203], v[48:51]
    s_waitcnt lgkmcnt(12)
    v_mfma_f32_16x16x32_bf16 v[60:63], v[140:143], v[200:203], v[60:63]
    v_mfma_f32_16x16x32_bf16 v[56:59], v[140:143], v[196:199], v[56:59]
    v_mfma_f32_16x16x32_bf16 v[52:55], v[140:143], v[192:195], v[52:55]
    s_waitcnt lgkmcnt(0)
    s_barrier
    v_mfma_f32_16x16x32_bf16 v[64:67], v[144:147], v[192:195], v[64:67]
    ds_read_b64 v[168:169], v20
    ds_read_b64 v[170:171], v21
    v_mfma_f32_16x16x32_bf16 v[68:71], v[144:147], v[196:199], v[68:71]
    ds_read_b64 v[172:173], v20 offset:4096
    ds_read_b64 v[174:175], v21 offset:4096
    v_mfma_f32_16x16x32_bf16 v[72:75], v[144:147], v[200:203], v[72:75]
    ds_read_b64 v[176:177], v20 offset:8192
    ds_read_b64 v[178:179], v21 offset:8192
    v_mfma_f32_16x16x32_bf16 v[84:87], v[148:151], v[200:203], v[84:87]
    v_cvt_pk_bf16_f32 v204, v40, v41
    v_cvt_pk_bf16_f32 v205, v42, v43
    v_mfma_f32_16x16x32_bf16 v[80:83], v[148:151], v[196:199], v[80:83]
    v_cvt_pk_bf16_f32 v206, v52, v53
    v_cvt_pk_bf16_f32 v207, v54, v55
L_pad4:
    s_cbranch_execz L_pad8
    v_mfma_f32_16x16x32_bf16 v[76:79], v[148:151], v[192:195], v[76:79]
    v_cvt_pk_bf16_f32 v220, v44, v45
    v_cvt_pk_bf16_f32 v221, v46, v47
    v_mfma_f32_16x16x32_bf16 v[88:91], v[152:155], v[192:195], v[88:91]
    v_cvt_pk_bf16_f32 v222, v56, v57
    v_cvt_pk_bf16_f32 v223, v58, v59
    v_mfma_f32_16x16x32_bf16 v[92:95], v[152:155], v[196:199], v[92:95]
    v_cvt_pk_bf16_f32 v236, v48, v49
    v_cvt_pk_bf16_f32 v237, v50, v51
    v_mfma_f32_16x16x32_bf16 v[96:99], v[152:155], v[200:203], v[96:99]
    v_cvt_pk_bf16_f32 v238, v60, v61
    v_cvt_pk_bf16_f32 v239, v62, v63
    v_mfma_f32_16x16x32_bf16 v[108:111], v[156:159], v[200:203], v[108:111]
    ds_read_b64 v[180:181], v20 offset:12288
    ds_read_b64 v[182:183], v21 offset:12288
    v_mfma_f32_16x16x32_bf16 v[104:107], v[156:159], v[196:199], v[104:107]
    ds_read_b64 v[184:185], v20 offset:16384
    ds_read_b64 v[186:187], v21 offset:16384
    v_mfma_f32_16x16x32_bf16 v[100:103], v[156:159], v[192:195], v[100:103]
    ds_read_b64 v[188:189], v20 offset:20480
    ds_read_b64 v[190:191], v21 offset:20480
    v_mfma_f32_16x16x32_bf16 v[112:115], v[160:163], v[192:195], v[112:115]
    v_cvt_pk_bf16_f32 v208, v64, v65
    v_cvt_pk_bf16_f32 v209, v66, v67
    v_mfma_f32_16x16x32_bf16 v[116:119], v[160:163], v[196:199], v[116:119]
    v_cvt_pk_bf16_f32 v210, v76, v77
    v_cvt_pk_bf16_f32 v211, v78, v79
    v_mfma_f32_16x16x32_bf16 v[120:123], v[160:163], v[200:203], v[120:123]
    v_cvt_pk_bf16_f32 v224, v68, v69
    v_cvt_pk_bf16_f32 v225, v70, v71
    v_mfma_f32_16x16x32_bf16 v[132:135], v[164:167], v[200:203], v[132:135]
    v_cvt_pk_bf16_f32 v226, v80, v81
    v_cvt_pk_bf16_f32 v227, v82, v83
    v_mfma_f32_16x16x32_bf16 v[128:131], v[164:167], v[196:199], v[128:131]
    v_cvt_pk_bf16_f32 v240, v72, v73
    v_cvt_pk_bf16_f32 v241, v74, v75
    v_mfma_f32_16x16x32_bf16 v[124:127], v[164:167], v[192:195], v[124:127]
    v_cvt_pk_bf16_f32 v242, v84, v85
    v_cvt_pk_bf16_f32 v243, v86, v87
    s_waitcnt lgkmcnt(10)
    v_mfma_f32_16x16x32_bf16 v[40:43], v[168:171], v[204:207], 0
    ds_read_b64 v[136:137], v22
    ds_read_b64 v[138:139], v23
    v_mfma_f32_16x16x32_bf16 v[44:47], v[168:171], v[220:223], 0
    v_cvt_pk_bf16_f32 v212, v88, v89
    v_cvt_pk_bf16_f32 v213, v90, v91
    v_mfma_f32_16x16x32_bf16 v[48:51], v[168:171], v[236:239], 0
    v_cvt_pk_bf16_f32 v214, v100, v101
    v_cvt_pk_bf16_f32 v215, v102, v103
    s_waitcnt lgkmcnt(10)
    v_mfma_f32_16x16x32_bf16 v[60:63], v[172:175], v[236:239], 0
    ds_read_b64 v[140:141], v22 offset:4096
    ds_read_b64 v[142:143], v23 offset:4096
    v_mfma_f32_16x16x32_bf16 v[56:59], v[172:175], v[220:223], 0
    v_cvt_pk_bf16_f32 v228, v92, v93
    v_cvt_pk_bf16_f32 v229, v94, v95
    v_mfma_f32_16x16x32_bf16 v[52:55], v[172:175], v[204:207], 0
    v_cvt_pk_bf16_f32 v230, v104, v105
    v_cvt_pk_bf16_f32 v231, v106, v107
    s_waitcnt lgkmcnt(10)
    v_mfma_f32_16x16x32_bf16 v[64:67], v[176:179], v[204:207], 0
    ds_read_b64 v[144:145], v22 offset:8192
    ds_read_b64 v[146:147], v23 offset:8192
    v_mfma_f32_16x16x32_bf16 v[68:71], v[176:179], v[220:223], 0
    v_cvt_pk_bf16_f32 v244, v96, v97
    v_cvt_pk_bf16_f32 v245, v98, v99
    v_mfma_f32_16x16x32_bf16 v[72:75], v[176:179], v[236:239], 0
    v_cvt_pk_bf16_f32 v246, v108, v109
    v_cvt_pk_bf16_f32 v247, v110, v111
    s_waitcnt lgkmcnt(10)
    v_mfma_f32_16x16x32_bf16 v[84:87], v[180:183], v[236:239], 0
    ds_read_b64 v[148:149], v22 offset:12288
    ds_read_b64 v[150:151], v23 offset:12288
    v_mfma_f32_16x16x32_bf16 v[80:83], v[180:183], v[220:223], 0
    v_cvt_pk_bf16_f32 v216, v112, v113
    v_cvt_pk_bf16_f32 v217, v114, v115
    v_mfma_f32_16x16x32_bf16 v[76:79], v[180:183], v[204:207], 0
    v_cvt_pk_bf16_f32 v218, v124, v125
    v_cvt_pk_bf16_f32 v219, v126, v127
    s_waitcnt lgkmcnt(10)
    v_mfma_f32_16x16x32_bf16 v[88:91], v[184:187], v[204:207], 0
    ds_read_b64 v[152:153], v22 offset:16384
    ds_read_b64 v[154:155], v23 offset:16384
    v_mfma_f32_16x16x32_bf16 v[92:95], v[184:187], v[220:223], 0
    v_cvt_pk_bf16_f32 v232, v116, v117
    v_cvt_pk_bf16_f32 v233, v118, v119
    v_mfma_f32_16x16x32_bf16 v[96:99], v[184:187], v[236:239], 0
    v_cvt_pk_bf16_f32 v234, v128, v129
    v_cvt_pk_bf16_f32 v235, v130, v131
    s_waitcnt lgkmcnt(10)
    v_mfma_f32_16x16x32_bf16 v[108:111], v[188:191], v[236:239], 0
    ds_read_b64 v[156:157], v22 offset:20480
    ds_read_b64 v[158:159], v23 offset:20480
    v_mfma_f32_16x16x32_bf16 v[104:107], v[188:191], v[220:223], 0
    v_cvt_pk_bf16_f32 v248, v120, v121
    v_cvt_pk_bf16_f32 v249, v122, v123
    v_mfma_f32_16x16x32_bf16 v[100:103], v[188:191], v[204:207], 0
    v_cvt_pk_bf16_f32 v250, v132, v133
    v_cvt_pk_bf16_f32 v251, v134, v135
    s_waitcnt lgkmcnt(10)
    v_mfma_f32_16x16x32_bf16 v[40:43], v[136:139], v[208:211], v[40:43]
    ds_read_b64 v[160:161], v24
    ds_read_b64 v[162:163], v25
    v_mfma_f32_16x16x32_bf16 v[44:47], v[136:139], v[224:227], v[44:47]
    v_mfma_f32_16x16x32_bf16 v[48:51], v[136:139], v[240:243], v[48:51]
    s_waitcnt lgkmcnt(10)
    v_mfma_f32_16x16x32_bf16 v[60:63], v[140:143], v[240:243], v[60:63]
    ds_read_b64 v[164:165], v26
    ds_read_b64 v[166:167], v27
    v_mfma_f32_16x16x32_bf16 v[56:59], v[140:143], v[224:227], v[56:59]
    v_mfma_f32_16x16x32_bf16 v[52:55], v[140:143], v[208:211], v[52:55]
    s_waitcnt lgkmcnt(10)
    v_mfma_f32_16x16x32_bf16 v[64:67], v[144:147], v[208:211], v[64:67]
    ds_read_b64 v[168:169], v24 offset:4096
    ds_read_b64 v[170:171], v25 offset:4096
    v_mfma_f32_16x16x32_bf16 v[68:71], v[144:147], v[224:227], v[68:71]
    v_mfma_f32_16x16x32_bf16 v[72:75], v[144:147], v[240:243], v[72:75]
    s_waitcnt lgkmcnt(10)
    v_mfma_f32_16x16x32_bf16 v[84:87], v[148:151], v[240:243], v[84:87]
    ds_read_b64 v[172:173], v26 offset:4096
    ds_read_b64 v[174:175], v27 offset:4096
    v_mfma_f32_16x16x32_bf16 v[80:83], v[148:151], v[224:227], v[80:83]
    v_mfma_f32_16x16x32_bf16 v[76:79], v[148:151], v[208:211], v[76:79]
    s_waitcnt lgkmcnt(10)
    v_mfma_f32_16x16x32_bf16 v[88:91], v[152:155], v[208:211], v[88:91]
    ds_read_b64 v[176:177], v24 offset:8192
    ds_read_b64 v[178:179], v25 offset:8192
    v_mfma_f32_16x16x32_bf16 v[92:95], v[152:155], v[224:227], v[92:95]
    v_mfma_f32_16x16x32_bf16 v[96:99], v[152:155], v[240:243], v[96:99]
    s_waitcnt lgkmcnt(10)
    v_mfma_f32_16x16x32_bf16 v[108:111], v[156:159], v[240:243], v[108:111]
    ds_read_b64 v[180:181], v26 offset:8192
    ds_read_b64 v[182:183], v27 offset:8192
    v_mfma_f32_16x16x32_bf16 v[104:107], v[156:159], v[224:227], v[104:107]
    v_mfma_f32_16x16x32_bf16 v[100:103], v[156:159], v[208:211], v[100:103]
    s_waitcnt lgkmcnt(10)
    v_mfma_f32_16x16x32_bf16 v[40:43], v[160:163], v[212:215], v[40:43]
    ds_read_b64 v[184:185], v24 offset:12288
    ds_read_b64 v[186:187], v25 offset:12288
    v_mfma_f32_16x16x32_bf16 v[44:47], v[160:163], v[228:231], v[44:47]
    v_mfma_f32_16x16x32_bf16 v[48:51], v[160:163], v[244:247], v[48:51]
    s_waitcnt lgkmcnt(10)
    v_mfma_f32_16x16x32_bf16 v[40:43], v[164:167], v[216:219], v[40:43]
    ds_read_b64 v[188:189], v26 offset:12288
    ds_read_b64 v[190:191], v27 offset:12288
    v_mfma_f32_16x16x32_bf16 v[44:47], v[164:167], v[232:235], v[44:47]
    v_mfma_f32_16x16x32_bf16 v[48:51], v[164:167], v[248:251], v[48:51]
    s_waitcnt lgkmcnt(10)
    v_mfma_f32_16x16x32_bf16 v[52:55], v[168:171], v[212:215], v[52:55]
    ds_read_b64 v[136:137], v24 offset:16384
    ds_read_b64 v[138:139], v25 offset:16384
    v_mfma_f32_16x16x32_bf16 v[56:59], v[168:171], v[228:231], v[56:59]
    v_mfma_f32_16x16x32_bf16 v[60:63], v[168:171], v[244:247], v[60:63]
    s_waitcnt lgkmcnt(10)
    v_mfma_f32_16x16x32_bf16 v[52:55], v[172:175], v[216:219], v[52:55]
    ds_read_b64 v[140:141], v26 offset:16384
    ds_read_b64 v[142:143], v27 offset:16384
    v_mfma_f32_16x16x32_bf16 v[56:59], v[172:175], v[232:235], v[56:59]
    v_max3_f32 v2, v40, v41, v42
    v_max_f32 v2, v43, v2
    v_mfma_f32_16x16x32_bf16 v[60:63], v[172:175], v[248:251], v[60:63]
    v_max3_f32 v4, v44, v45, v46
    v_max_f32 v4, v47, v4
    s_waitcnt lgkmcnt(10)
    v_mfma_f32_16x16x32_bf16 v[64:67], v[176:179], v[212:215], v[64:67]
    ds_read_b64 v[144:145], v24 offset:20480
    ds_read_b64 v[146:147], v25 offset:20480
    v_mfma_f32_16x16x32_bf16 v[68:71], v[176:179], v[228:231], v[68:71]
    v_max3_f32 v6, v48, v49, v50
    v_max_f32 v6, v51, v6
    v_mfma_f32_16x16x32_bf16 v[72:75], v[176:179], v[244:247], v[72:75]
    s_waitcnt lgkmcnt(10)
    v_mfma_f32_16x16x32_bf16 v[64:67], v[180:183], v[216:219], v[64:67]
    ds_read_b64 v[148:149], v26 offset:20480
    ds_read_b64 v[150:151], v27 offset:20480
    v_mfma_f32_16x16x32_bf16 v[68:71], v[180:183], v[232:235], v[68:71]
    v_max3_f32 v2, v52, v53, v2
    v_max3_f32 v2, v54, v55, v2
    v_mfma_f32_16x16x32_bf16 v[72:75], v[180:183], v[248:251], v[72:75]
    v_max3_f32 v4, v56, v57, v4
    v_max3_f32 v4, v58, v59, v4
    s_waitcnt lgkmcnt(10)
    v_mfma_f32_16x16x32_bf16 v[76:79], v[184:187], v[212:215], v[76:79]
    v_max3_f32 v6, v60, v61, v6
    v_max3_f32 v6, v62, v63, v6
    v_mfma_f32_16x16x32_bf16 v[80:83], v[184:187], v[228:231], v[80:83]
    v_mfma_f32_16x16x32_bf16 v[84:87], v[184:187], v[244:247], v[84:87]
    s_waitcnt lgkmcnt(8)
    v_mfma_f32_16x16x32_bf16 v[76:79], v[188:191], v[216:219], v[76:79]
    v_max3_f32 v2, v64, v65, v2
    v_max3_f32 v2, v66, v67, v2
    v_mfma_f32_16x16x32_bf16 v[80:83], v[188:191], v[232:235], v[80:83]
    v_max3_f32 v4, v68, v69, v4
    v_max3_f32 v4, v70, v71, v4
    v_mfma_f32_16x16x32_bf16 v[84:87], v[188:191], v[248:251], v[84:87]
    v_max3_f32 v6, v72, v73, v6
    v_max3_f32 v6, v74, v75, v6
    s_waitcnt lgkmcnt(6)
    v_mfma_f32_16x16x32_bf16 v[88:91], v[136:139], v[212:215], v[88:91]
    v_mfma_f32_16x16x32_bf16 v[92:95], v[136:139], v[228:231], v[92:95]
    v_mfma_f32_16x16x32_bf16 v[96:99], v[136:139], v[244:247], v[96:99]
    s_waitcnt lgkmcnt(4)
    v_mfma_f32_16x16x32_bf16 v[88:91], v[140:143], v[216:219], v[88:91]
    v_max3_f32 v2, v76, v77, v2
    v_max3_f32 v2, v78, v79, v2
    v_mfma_f32_16x16x32_bf16 v[92:95], v[140:143], v[232:235], v[92:95]
    v_max3_f32 v4, v80, v81, v4
    v_max3_f32 v4, v82, v83, v4
    v_mfma_f32_16x16x32_bf16 v[96:99], v[140:143], v[248:251], v[96:99]
    v_max3_f32 v6, v84, v85, v6
    v_max3_f32 v6, v86, v87, v6
    s_waitcnt lgkmcnt(2)
    v_mfma_f32_16x16x32_bf16 v[100:103], v[144:147], v[212:215], v[100:103]
    v_mfma_f32_16x16x32_bf16 v[104:107], v[144:147], v[228:231], v[104:107]
    v_mfma_f32_16x16x32_bf16 v[108:111], v[144:147], v[244:247], v[108:111]
    s_waitcnt lgkmcnt(0)
    v_mfma_f32_16x16x32_bf16 v[100:103], v[148:151], v[216:219], v[100:103]
    v_max3_f32 v2, v88, v89, v2
    v_max3_f32 v2, v90, v91, v2
    v_mfma_f32_16x16x32_bf16 v[104:107], v[148:151], v[232:235], v[104:107]
    v_max3_f32 v4, v92, v93, v4
    v_max3_f32 v4, v94, v95, v4
    v_mfma_f32_16x16x32_bf16 v[108:111], v[148:151], v[248:251], v[108:111]
    v_max3_f32 v6, v96, v97, v6
    v_max3_f32 v6, v98, v99, v6
    s_waitcnt lgkmcnt(0)
    s_barrier
    v_max3_f32 v2, v100, v101, v2
    v_max3_f32 v4, v104, v105, v4
    s_nop 1
    v_max3_f32 v6, v108, v109, v6
    v_max3_f32 v2, v102, v103, v2
    v_max3_f32 v4, v106, v107, v4
    v_max3_f32 v6, v110, v111, v6
    v_mov_b32 v3, v2
    v_mov_b32 v5, v4
    v_mov_b32 v7, v6
    v_permlane16_swap_b32 v2, v3
    v_permlane16_swap_b32 v4, v5
    v_permlane16_swap_b32 v6, v7
    v_max_f32 v2, v3, v2
    v_max_f32 v4, v5, v4
    v_max_f32 v6, v7, v6
    v_mov_b32 v3, v2
    v_mov_b32 v5, v4
    v_mov_b32 v7, v6
    v_permlane32_swap_b32 v2, v3
    v_permlane32_swap_b32 v4, v5
    v_permlane32_swap_b32 v6, v7
    v_max_f32 v2, v3, v2
    v_max_f32 v4, v5, v4
    v_max_f32 v6, v7, v6
    v_mul_f32 v2, s76, v2
    v_mul_f32 v4, s76, v4
    v_mul_f32 v6, s76, v6
    v_mov_b32 v240, 0x3f803f80
    v_mov_b32 v241, 0x3f803f80
    v_mov_b32 v242, 0x3f803f80
    v_mov_b32 v243, 0x3f803f80
    v_pk_fma_f32 v[40:41], v[40:41], s[76:77], v[2:3] op_sel_hi:[1,0,0] neg_lo:[0,0,1] neg_hi:[0,0,1]
    v_pk_fma_f32 v[42:43], v[42:43], s[76:77], v[2:3] op_sel_hi:[1,0,0] neg_lo:[0,0,1] neg_hi:[0,0,1]
    v_pk_fma_f32 v[44:45], v[44:45], s[76:77], v[4:5] op_sel_hi:[1,0,0] neg_lo:[0,0,1] neg_hi:[0,0,1]
    v_pk_fma_f32 v[46:47], v[46:47], s[76:77], v[4:5] op_sel_hi:[1,0,0] neg_lo:[0,0,1] neg_hi:[0,0,1]
    v_pk_fma_f32 v[48:49], v[48:49], s[76:77], v[6:7] op_sel_hi:[1,0,0] neg_lo:[0,0,1] neg_hi:[0,0,1]
    v_pk_fma_f32 v[50:51], v[50:51], s[76:77], v[6:7] op_sel_hi:[1,0,0] neg_lo:[0,0,1] neg_hi:[0,0,1]
    v_exp_f32 v40, v40
    v_exp_f32 v41, v41
    v_exp_f32 v42, v42
    v_exp_f32 v43, v43
    v_exp_f32 v44, v44
    v_exp_f32 v45, v45
    v_exp_f32 v46, v46
    v_exp_f32 v47, v47
    v_exp_f32 v48, v48
    v_exp_f32 v49, v49
    v_exp_f32 v50, v50
    v_exp_f32 v51, v51
    v_cvt_pk_bf16_f32 v204, v40, v41
    v_cvt_pk_bf16_f32 v205, v42, v43
    v_cvt_pk_bf16_f32 v216, v44, v45
    v_cvt_pk_bf16_f32 v217, v46, v47
    v_cvt_pk_bf16_f32 v228, v48, v49
    v_cvt_pk_bf16_f32 v229, v50, v51
    v_pk_fma_f32 v[52:53], v[52:53], s[76:77], v[2:3] op_sel_hi:[1,0,0] neg_lo:[0,0,1] neg_hi:[0,0,1]
    v_pk_fma_f32 v[54:55], v[54:55], s[76:77], v[2:3] op_sel_hi:[1,0,0] neg_lo:[0,0,1] neg_hi:[0,0,1]
    v_pk_fma_f32 v[56:57], v[56:57], s[76:77], v[4:5] op_sel_hi:[1,0,0] neg_lo:[0,0,1] neg_hi:[0,0,1]
    v_pk_fma_f32 v[58:59], v[58:59], s[76:77], v[4:5] op_sel_hi:[1,0,0] neg_lo:[0,0,1] neg_hi:[0,0,1]
    v_pk_fma_f32 v[60:61], v[60:61], s[76:77], v[6:7] op_sel_hi:[1,0,0] neg_lo:[0,0,1] neg_hi:[0,0,1]
    v_pk_fma_f32 v[62:63], v[62:63], s[76:77], v[6:7] op_sel_hi:[1,0,0] neg_lo:[0,0,1] neg_hi:[0,0,1]
    v_exp_f32 v52, v52
    v_exp_f32 v53, v53
    v_exp_f32 v54, v54
    v_exp_f32 v55, v55
    v_exp_f32 v56, v56
    v_exp_f32 v57, v57
    v_exp_f32 v58, v58
    v_exp_f32 v59, v59
    v_exp_f32 v60, v60
    v_exp_f32 v61, v61
    v_exp_f32 v62, v62
    v_exp_f32 v63, v63
    v_cvt_pk_bf16_f32 v206, v52, v53
    v_cvt_pk_bf16_f32 v207, v54, v55
    v_cvt_pk_bf16_f32 v218, v56, v57
    v_cvt_pk_bf16_f32 v219, v58, v59
    v_cvt_pk_bf16_f32 v230, v60, v61
    v_cvt_pk_bf16_f32 v231, v62, v63
    ds_read_b64_tr_b16 v[136:137], v28
    ds_read_b64_tr_b16 v[138:139], v28 offset:4096
    ds_read_b64_tr_b16 v[140:141], v29
    ds_read_b64_tr_b16 v[142:143], v29 offset:4096
    ds_read_b64_tr_b16 v[144:145], v28 offset:8192
    ds_read_b64_tr_b16 v[146:147], v28 offset:12288
    ds_read_b64_tr_b16 v[148:149], v29 offset:8192
    ds_read_b64_tr_b16 v[150:151], v29 offset:12288
    ds_read_b64_tr_b16 v[152:153], v28 offset:16384
    ds_read_b64_tr_b16 v[154:155], v28 offset:20480
    ds_read_b64_tr_b16 v[156:157], v29 offset:16384
    ds_read_b64_tr_b16 v[158:159], v29 offset:20480
    ds_read_b64_tr_b16 v[160:161], v30
    ds_read_b64_tr_b16 v[162:163], v30 offset:4096
    ds_read_b64_tr_b16 v[164:165], v31
    ds_read_b64_tr_b16 v[166:167], v31 offset:4096
    v_pk_fma_f32 v[64:65], v[64:65], s[76:77], v[2:3] op_sel_hi:[1,0,0] neg_lo:[0,0,1] neg_hi:[0,0,1]
    v_pk_fma_f32 v[66:67], v[66:67], s[76:77], v[2:3] op_sel_hi:[1,0,0] neg_lo:[0,0,1] neg_hi:[0,0,1]
    v_pk_fma_f32 v[68:69], v[68:69], s[76:77], v[4:5] op_sel_hi:[1,0,0] neg_lo:[0,0,1] neg_hi:[0,0,1]
    v_pk_fma_f32 v[70:71], v[70:71], s[76:77], v[4:5] op_sel_hi:[1,0,0] neg_lo:[0,0,1] neg_hi:[0,0,1]
    v_mfma_f32_16x16x32_bf16 v[40:43], v[240:243], v[204:207], 0
    v_pk_fma_f32 v[72:73], v[72:73], s[76:77], v[6:7] op_sel_hi:[1,0,0] neg_lo:[0,0,1] neg_hi:[0,0,1]
    v_pk_fma_f32 v[74:75], v[74:75], s[76:77], v[6:7] op_sel_hi:[1,0,0] neg_lo:[0,0,1] neg_hi:[0,0,1]
    v_exp_f32 v64, v64
    v_exp_f32 v65, v65
    v_mfma_f32_16x16x32_bf16 v[44:47], v[240:243], v[216:219], 0
    v_exp_f32 v66, v66
    v_exp_f32 v67, v67
    v_exp_f32 v68, v68
    v_exp_f32 v69, v69
    v_mfma_f32_16x16x32_bf16 v[48:51], v[240:243], v[228:231], 0
    v_exp_f32 v70, v70
    v_exp_f32 v71, v71
    v_exp_f32 v72, v72
    v_exp_f32 v73, v73
    s_waitcnt lgkmcnt(14)
    v_mfma_f32_16x16x32_bf16 v[112:115], v[136:139], v[204:207], 0
    v_exp_f32 v74, v74
    v_exp_f32 v75, v75
    v_cvt_pk_bf16_f32 v208, v64, v65
    v_cvt_pk_bf16_f32 v209, v66, v67
    v_mfma_f32_16x16x32_bf16 v[116:119], v[136:139], v[216:219], 0
    v_cvt_pk_bf16_f32 v220, v68, v69
    v_cvt_pk_bf16_f32 v221, v70, v71
    v_cvt_pk_bf16_f32 v232, v72, v73
    v_cvt_pk_bf16_f32 v233, v74, v75
    v_mfma_f32_16x16x32_bf16 v[120:123], v[136:139], v[228:231], 0
    v_pk_fma_f32 v[76:77], v[76:77], s[76:77], v[2:3] op_sel_hi:[1,0,0] neg_lo:[0,0,1] neg_hi:[0,0,1]
    v_pk_fma_f32 v[78:79], v[78:79], s[76:77], v[2:3] op_sel_hi:[1,0,0] neg_lo:[0,0,1] neg_hi:[0,0,1]
    v_pk_fma_f32 v[80:81], v[80:81], s[76:77], v[4:5] op_sel_hi:[1,0,0] neg_lo:[0,0,1] neg_hi:[0,0,1]
    v_pk_fma_f32 v[82:83], v[82:83], s[76:77], v[4:5] op_sel_hi:[1,0,0] neg_lo:[0,0,1] neg_hi:[0,0,1]
    s_waitcnt lgkmcnt(12)
    v_mfma_f32_16x16x32_bf16 v[132:135], v[140:143], v[228:231], 0
    v_pk_fma_f32 v[84:85], v[84:85], s[76:77], v[6:7] op_sel_hi:[1,0,0] neg_lo:[0,0,1] neg_hi:[0,0,1]
    v_pk_fma_f32 v[86:87], v[86:87], s[76:77], v[6:7] op_sel_hi:[1,0,0] neg_lo:[0,0,1] neg_hi:[0,0,1]
    v_exp_f32 v76, v76
    v_exp_f32 v77, v77
    v_mfma_f32_16x16x32_bf16 v[128:131], v[140:143], v[216:219], 0
    v_exp_f32 v78, v78
    v_exp_f32 v79, v79
    v_exp_f32 v80, v80
    v_exp_f32 v81, v81
    v_mfma_f32_16x16x32_bf16 v[124:127], v[140:143], v[204:207], 0
    v_exp_f32 v82, v82
    v_exp_f32 v83, v83
    v_exp_f32 v84, v84
    v_exp_f32 v85, v85
    v_exp_f32 v86, v86
    v_exp_f32 v87, v87
    v_cvt_pk_bf16_f32 v210, v76, v77
    v_cvt_pk_bf16_f32 v211, v78, v79
    v_cvt_pk_bf16_f32 v222, v80, v81
    v_cvt_pk_bf16_f32 v223, v82, v83
    v_cvt_pk_bf16_f32 v234, v84, v85
    v_cvt_pk_bf16_f32 v235, v86, v87
    v_pk_fma_f32 v[88:89], v[88:89], s[76:77], v[2:3] op_sel_hi:[1,0,0] neg_lo:[0,0,1] neg_hi:[0,0,1]
    v_pk_fma_f32 v[90:91], v[90:91], s[76:77], v[2:3] op_sel_hi:[1,0,0] neg_lo:[0,0,1] neg_hi:[0,0,1]
    v_pk_fma_f32 v[92:93], v[92:93], s[76:77], v[4:5] op_sel_hi:[1,0,0] neg_lo:[0,0,1] neg_hi:[0,0,1]
    v_pk_fma_f32 v[94:95], v[94:95], s[76:77], v[4:5] op_sel_hi:[1,0,0] neg_lo:[0,0,1] neg_hi:[0,0,1]
    v_mfma_f32_16x16x32_bf16 v[40:43], v[240:243], v[208:211], v[40:43]
    v_pk_fma_f32 v[96:97], v[96:97], s[76:77], v[6:7] op_sel_hi:[1,0,0] neg_lo:[0,0,1] neg_hi:[0,0,1]
    v_pk_fma_f32 v[98:99], v[98:99], s[76:77], v[6:7] op_sel_hi:[1,0,0] neg_lo:[0,0,1] neg_hi:[0,0,1]
    v_exp_f32 v88, v88
    v_exp_f32 v89, v89
    v_mfma_f32_16x16x32_bf16 v[44:47], v[240:243], v[220:223], v[44:47]
    v_exp_f32 v90, v90
    v_exp_f32 v91, v91
    v_exp_f32 v92, v92
    v_exp_f32 v93, v93
    v_mfma_f32_16x16x32_bf16 v[48:51], v[240:243], v[232:235], v[48:51]
    v_exp_f32 v94, v94
    v_exp_f32 v95, v95
    v_exp_f32 v96, v96
    v_exp_f32 v97, v97
    s_waitcnt lgkmcnt(10)
    v_mfma_f32_16x16x32_bf16 v[112:115], v[144:147], v[208:211], v[112:115]
    v_exp_f32 v98, v98
    v_exp_f32 v99, v99
    v_cvt_pk_bf16_f32 v212, v88, v89
    v_cvt_pk_bf16_f32 v213, v90, v91
    v_mfma_f32_16x16x32_bf16 v[116:119], v[144:147], v[220:223], v[116:119]
    v_cvt_pk_bf16_f32 v224, v92, v93
    v_cvt_pk_bf16_f32 v225, v94, v95
    v_cvt_pk_bf16_f32 v236, v96, v97
    v_cvt_pk_bf16_f32 v237, v98, v99
    v_mfma_f32_16x16x32_bf16 v[120:123], v[144:147], v[232:235], v[120:123]
    v_pk_fma_f32 v[100:101], v[100:101], s[76:77], v[2:3] op_sel_hi:[1,0,0] neg_lo:[0,0,1] neg_hi:[0,0,1]
    v_pk_fma_f32 v[102:103], v[102:103], s[76:77], v[2:3] op_sel_hi:[1,0,0] neg_lo:[0,0,1] neg_hi:[0,0,1]
    v_pk_fma_f32 v[104:105], v[104:105], s[76:77], v[4:5] op_sel_hi:[1,0,0] neg_lo:[0,0,1] neg_hi:[0,0,1]
    v_pk_fma_f32 v[106:107], v[106:107], s[76:77], v[4:5] op_sel_hi:[1,0,0] neg_lo:[0,0,1] neg_hi:[0,0,1]
    s_waitcnt lgkmcnt(8)
    v_mfma_f32_16x16x32_bf16 v[132:135], v[148:151], v[232:235], v[132:135]
    v_pk_fma_f32 v[108:109], v[108:109], s[76:77], v[6:7] op_sel_hi:[1,0,0] neg_lo:[0,0,1] neg_hi:[0,0,1]
    v_pk_fma_f32 v[110:111], v[110:111], s[76:77], v[6:7] op_sel_hi:[1,0,0] neg_lo:[0,0,1] neg_hi:[0,0,1]
    v_exp_f32 v100, v100
    v_exp_f32 v101, v101
    v_mfma_f32_16x16x32_bf16 v[128:131], v[148:151], v[220:223], v[128:131]
    v_exp_f32 v102, v102
    v_exp_f32 v103, v103
    v_exp_f32 v104, v104
    v_exp_f32 v105, v105
    v_mfma_f32_16x16x32_bf16 v[124:127], v[148:151], v[208:211], v[124:127]
    v_exp_f32 v106, v106
    v_exp_f32 v107, v107
    v_exp_f32 v108, v108
    v_exp_f32 v109, v109
    v_exp_f32 v110, v110
    v_exp_f32 v111, v111
    v_cvt_pk_bf16_f32 v214, v100, v101
    v_cvt_pk_bf16_f32 v215, v102, v103
    v_cvt_pk_bf16_f32 v226, v104, v105
    v_cvt_pk_bf16_f32 v227, v106, v107
    v_cvt_pk_bf16_f32 v238, v108, v109
    v_cvt_pk_bf16_f32 v239, v110, v111
    v_mfma_f32_16x16x32_bf16 v[40:43], v[240:243], v[212:215], v[40:43]
    v_mfma_f32_16x16x32_bf16 v[44:47], v[240:243], v[224:227], v[44:47]
    v_mfma_f32_16x16x32_bf16 v[48:51], v[240:243], v[236:239], v[48:51]
    s_waitcnt lgkmcnt(6)
    v_mfma_f32_16x16x32_bf16 v[112:115], v[152:155], v[212:215], v[112:115]
    ds_read_b64_tr_b16 v[168:169], v30 offset:8192
    ds_read_b64_tr_b16 v[170:171], v30 offset:12288
    ds_read_b64_tr_b16 v[172:173], v31 offset:8192
    v_mfma_f32_16x16x32_bf16 v[116:119], v[152:155], v[224:227], v[116:119]
    ds_read_b64_tr_b16 v[174:175], v31 offset:12288
    v_mfma_f32_16x16x32_bf16 v[120:123], v[152:155], v[236:239], v[120:123]
    s_waitcnt lgkmcnt(8)
    v_mfma_f32_16x16x32_bf16 v[132:135], v[156:159], v[236:239], v[132:135]
    ds_read_b64_tr_b16 v[176:177], v30 offset:16384
    ds_read_b64_tr_b16 v[178:179], v30 offset:20480
    ds_read_b64_tr_b16 v[136:137], v31 offset:16384
    v_mfma_f32_16x16x32_bf16 v[128:131], v[156:159], v[224:227], v[128:131]
    ds_read_b64_tr_b16 v[138:139], v31 offset:20480
    v_mfma_f32_16x16x32_bf16 v[124:127], v[156:159], v[212:215], v[124:127]
    s_waitcnt lgkmcnt(10)
    v_mfma_f32_16x16x32_bf16 v[64:67], v[160:163], v[204:207], 0
    ds_read_b64_tr_b16 v[140:141], v32
    ds_read_b64_tr_b16 v[142:143], v32 offset:4096
    ds_read_b64_tr_b16 v[144:145], v33
    v_mfma_f32_16x16x32_bf16 v[68:71], v[160:163], v[216:219], 0
    ds_read_b64_tr_b16 v[146:147], v33 offset:4096
    v_mfma_f32_16x16x32_bf16 v[72:75], v[160:163], v[228:231], 0
    s_waitcnt lgkmcnt(12)
    v_mfma_f32_16x16x32_bf16 v[84:87], v[164:167], v[228:231], 0
    ds_read_b64_tr_b16 v[148:149], v32 offset:8192
    ds_read_b64_tr_b16 v[150:151], v32 offset:12288
    v_rcp_f32 v2, v40
    v_mfma_f32_16x16x32_bf16 v[80:83], v[164:167], v[216:219], 0
    v_rcp_f32 v4, v44
    v_rcp_f32 v6, v48
    v_mul_f32 v112, v2, v112
    v_mfma_f32_16x16x32_bf16 v[76:79], v[164:167], v[204:207], 0
    v_mul_f32 v113, v2, v113
    v_mul_f32 v114, v2, v114
    v_mul_f32 v115, v2, v115
    s_waitcnt lgkmcnt(12)
    v_mfma_f32_16x16x32_bf16 v[64:67], v[168:171], v[208:211], v[64:67]
    ds_read_b64_tr_b16 v[152:153], v33 offset:8192
    ds_read_b64_tr_b16 v[154:155], v33 offset:12288
    v_mul_f32 v124, v2, v124
    v_mfma_f32_16x16x32_bf16 v[68:71], v[168:171], v[220:223], v[68:71]
    v_mul_f32 v125, v2, v125
    v_mul_f32 v126, v2, v126
    v_mul_f32 v127, v2, v127
    v_mfma_f32_16x16x32_bf16 v[72:75], v[168:171], v[232:235], v[72:75]
    v_cvt_pk_bf16_f32 v180, v112, v113
    v_cvt_pk_bf16_f32 v181, v114, v115
    v_cvt_pk_bf16_f32 v182, v124, v125
    s_waitcnt lgkmcnt(12)
    v_mfma_f32_16x16x32_bf16 v[84:87], v[172:175], v[232:235], v[84:87]
    ds_read_b64_tr_b16 v[156:157], v32 offset:16384
    ds_read_b64_tr_b16 v[158:159], v32 offset:20480
    v_cvt_pk_bf16_f32 v183, v126, v127
    v_mfma_f32_16x16x32_bf16 v[80:83], v[172:175], v[220:223], v[80:83]
    buffer_store_dwordx4 v[180:183], v36, s[28:31], 0 offen sc1
    v_mul_f32 v116, v4, v116
    v_mul_f32 v117, v4, v117
    v_mfma_f32_16x16x32_bf16 v[76:79], v[172:175], v[208:211], v[76:79]
    v_mul_f32 v118, v4, v118
    v_mul_f32 v119, v4, v119
    v_mul_f32 v128, v4, v128
    s_waitcnt lgkmcnt(12)
    v_mfma_f32_16x16x32_bf16 v[64:67], v[176:179], v[212:215], v[64:67]
    ds_read_b64_tr_b16 v[160:161], v33 offset:16384
    ds_read_b64_tr_b16 v[162:163], v33 offset:20480
    v_mul_f32 v129, v4, v129
    v_mfma_f32_16x16x32_bf16 v[68:71], v[176:179], v[224:227], v[68:71]
    v_mul_f32 v130, v4, v130
    v_mul_f32 v131, v4, v131
    v_cvt_pk_bf16_f32 v184, v116, v117
    v_mfma_f32_16x16x32_bf16 v[72:75], v[176:179], v[236:239], v[72:75]
    v_cvt_pk_bf16_f32 v185, v118, v119
    v_cvt_pk_bf16_f32 v186, v128, v129
    v_cvt_pk_bf16_f32 v187, v130, v131
    s_waitcnt lgkmcnt(12)
    v_mfma_f32_16x16x32_bf16 v[84:87], v[136:139], v[236:239], v[84:87]
    ds_read_b64_tr_b16 v[164:165], v34
    ds_read_b64_tr_b16 v[166:167], v34 offset:4096
    buffer_store_dwordx4 v[184:187], v36, s[28:31], s81 offen sc1
    v_mfma_f32_16x16x32_bf16 v[80:83], v[136:139], v[224:227], v[80:83]
    v_mul_f32 v120, v6, v120
    v_mul_f32 v121, v6, v121
    v_mul_f32 v122, v6, v122
    v_mfma_f32_16x16x32_bf16 v[76:79], v[136:139], v[212:215], v[76:79]
    v_mul_f32 v123, v6, v123
    v_mul_f32 v132, v6, v132
    v_mul_f32 v133, v6, v133
    s_waitcnt lgkmcnt(12)
    v_mfma_f32_16x16x32_bf16 v[88:91], v[140:143], v[204:207], 0
    ds_read_b64_tr_b16 v[168:169], v35
    ds_read_b64_tr_b16 v[170:171], v35 offset:4096
    v_mul_f32 v134, v6, v134
    v_mfma_f32_16x16x32_bf16 v[92:95], v[140:143], v[216:219], 0
    v_mul_f32 v135, v6, v135
    v_cvt_pk_bf16_f32 v188, v120, v121
    v_cvt_pk_bf16_f32 v189, v122, v123
    v_mfma_f32_16x16x32_bf16 v[96:99], v[140:143], v[228:231], 0
    v_cvt_pk_bf16_f32 v190, v132, v133
    v_cvt_pk_bf16_f32 v191, v134, v135
    buffer_store_dwordx4 v[188:191], v36, s[28:31], s82 offen sc1
    s_waitcnt lgkmcnt(12)
    v_mfma_f32_16x16x32_bf16 v[108:111], v[144:147], v[228:231], 0
    ds_read_b64_tr_b16 v[172:173], v34 offset:8192
    ds_read_b64_tr_b16 v[174:175], v34 offset:12288
    v_mul_f32 v64, v2, v64
    v_mfma_f32_16x16x32_bf16 v[104:107], v[144:147], v[216:219], 0
    v_mul_f32 v65, v2, v65
    v_mul_f32 v66, v2, v66
    v_mul_f32 v67, v2, v67
    v_mfma_f32_16x16x32_bf16 v[100:103], v[144:147], v[204:207], 0
    v_mul_f32 v76, v2, v76
    v_mul_f32 v77, v2, v77
    v_mul_f32 v78, v2, v78
    s_waitcnt lgkmcnt(12)
    v_mfma_f32_16x16x32_bf16 v[88:91], v[148:151], v[208:211], v[88:91]
    ds_read_b64_tr_b16 v[176:177], v35 offset:8192
    ds_read_b64_tr_b16 v[178:179], v35 offset:12288
    v_mul_f32 v79, v2, v79
    v_mfma_f32_16x16x32_bf16 v[92:95], v[148:151], v[220:223], v[92:95]
    v_cvt_pk_bf16_f32 v192, v64, v65
    v_cvt_pk_bf16_f32 v193, v66, v67
    v_cvt_pk_bf16_f32 v194, v76, v77
    v_mfma_f32_16x16x32_bf16 v[96:99], v[148:151], v[232:235], v[96:99]
    v_cvt_pk_bf16_f32 v195, v78, v79
    buffer_store_dwordx4 v[192:195], v36, s[28:31], 0 offen offset:1024 sc1
    v_mul_f32 v68, v4, v68
    s_waitcnt lgkmcnt(12)
    v_mfma_f32_16x16x32_bf16 v[108:111], v[152:155], v[232:235], v[108:111]
    ds_read_b64_tr_b16 v[136:137], v34 offset:16384
    ds_read_b64_tr_b16 v[138:139], v34 offset:20480
    v_mul_f32 v69, v4, v69
    v_mfma_f32_16x16x32_bf16 v[104:107], v[152:155], v[220:223], v[104:107]
    v_mul_f32 v70, v4, v70
    v_mul_f32 v71, v4, v71
    v_mul_f32 v80, v4, v80
    v_mfma_f32_16x16x32_bf16 v[100:103], v[152:155], v[208:211], v[100:103]
    v_mul_f32 v81, v4, v81
    v_mul_f32 v82, v4, v82
    v_mul_f32 v83, v4, v83
    s_waitcnt lgkmcnt(12)
    v_mfma_f32_16x16x32_bf16 v[88:91], v[156:159], v[212:215], v[88:91]
    ds_read_b64_tr_b16 v[140:141], v35 offset:16384
    ds_read_b64_tr_b16 v[142:143], v35 offset:20480
    v_cvt_pk_bf16_f32 v196, v68, v69
    v_mfma_f32_16x16x32_bf16 v[92:95], v[156:159], v[224:227], v[92:95]
    v_cvt_pk_bf16_f32 v197, v70, v71
    v_cvt_pk_bf16_f32 v198, v80, v81
    v_cvt_pk_bf16_f32 v199, v82, v83
    v_mfma_f32_16x16x32_bf16 v[96:99], v[156:159], v[236:239], v[96:99]
    buffer_store_dwordx4 v[196:199], v36, s[28:31], s81 offen offset:1024 sc1
    v_mul_f32 v72, v6, v72
    v_mul_f32 v73, v6, v73
    s_waitcnt lgkmcnt(12)
    v_mfma_f32_16x16x32_bf16 v[108:111], v[160:163], v[236:239], v[108:111]
    v_mul_f32 v74, v6, v74
    v_mul_f32 v75, v6, v75
    v_mul_f32 v84, v6, v84
    v_mfma_f32_16x16x32_bf16 v[104:107], v[160:163], v[224:227], v[104:107]
    v_mul_f32 v85, v6, v85
    v_mul_f32 v86, v6, v86
    v_mul_f32 v87, v6, v87
L_pad5:
    s_cbranch_execz L_pad9
    v_mfma_f32_16x16x32_bf16 v[100:103], v[160:163], v[212:215], v[100:103]
    v_cvt_pk_bf16_f32 v200, v72, v73
    v_cvt_pk_bf16_f32 v201, v74, v75
    v_cvt_pk_bf16_f32 v202, v84, v85
    s_waitcnt lgkmcnt(10)
    v_mfma_f32_16x16x32_bf16 v[112:115], v[164:167], v[204:207], 0
    v_cvt_pk_bf16_f32 v203, v86, v87
    buffer_store_dwordx4 v[200:203], v36, s[28:31], s82 offen offset:1024 sc1
    v_mfma_f32_16x16x32_bf16 v[116:119], v[164:167], v[216:219], 0
    v_mfma_f32_16x16x32_bf16 v[120:123], v[164:167], v[228:231], 0
    s_waitcnt lgkmcnt(8)
    v_mfma_f32_16x16x32_bf16 v[132:135], v[168:171], v[228:231], 0
    v_mul_f32 v88, v2, v88
    v_mul_f32 v89, v2, v89
    v_mul_f32 v90, v2, v90
    v_mfma_f32_16x16x32_bf16 v[128:131], v[168:171], v[216:219], 0
    v_mul_f32 v91, v2, v91
    v_mul_f32 v100, v2, v100
    v_mul_f32 v101, v2, v101
    v_mfma_f32_16x16x32_bf16 v[124:127], v[168:171], v[204:207], 0
    v_mul_f32 v102, v2, v102
    v_mul_f32 v103, v2, v103
    v_cvt_pk_bf16_f32 v180, v88, v89
    s_waitcnt lgkmcnt(6)
    v_mfma_f32_16x16x32_bf16 v[112:115], v[172:175], v[208:211], v[112:115]
    v_cvt_pk_bf16_f32 v181, v90, v91
    v_cvt_pk_bf16_f32 v182, v100, v101
    v_cvt_pk_bf16_f32 v183, v102, v103
    v_mfma_f32_16x16x32_bf16 v[116:119], v[172:175], v[220:223], v[116:119]
    buffer_store_dwordx4 v[180:183], v36, s[28:31], 0 offen offset:2048 sc1
    v_mul_f32 v92, v4, v92
    v_mul_f32 v93, v4, v93
    v_mfma_f32_16x16x32_bf16 v[120:123], v[172:175], v[232:235], v[120:123]
    v_mul_f32 v94, v4, v94
    v_mul_f32 v95, v4, v95
    v_mul_f32 v104, v4, v104
    s_waitcnt lgkmcnt(4)
    v_mfma_f32_16x16x32_bf16 v[132:135], v[176:179], v[232:235], v[132:135]
    v_mul_f32 v105, v4, v105
    v_mul_f32 v106, v4, v106
    v_mul_f32 v107, v4, v107
    v_mfma_f32_16x16x32_bf16 v[128:131], v[176:179], v[220:223], v[128:131]
    v_cvt_pk_bf16_f32 v184, v92, v93
    v_cvt_pk_bf16_f32 v185, v94, v95
    v_cvt_pk_bf16_f32 v186, v104, v105
    v_mfma_f32_16x16x32_bf16 v[124:127], v[176:179], v[208:211], v[124:127]
    v_cvt_pk_bf16_f32 v187, v106, v107
    buffer_store_dwordx4 v[184:187], v36, s[28:31], s81 offen offset:2048 sc1
    v_mul_f32 v96, v6, v96
    s_waitcnt lgkmcnt(2)
    v_mfma_f32_16x16x32_bf16 v[112:115], v[136:139], v[212:215], v[112:115]
    v_mul_f32 v97, v6, v97
    v_mul_f32 v98, v6, v98
    v_mul_f32 v99, v6, v99
    v_mfma_f32_16x16x32_bf16 v[116:119], v[136:139], v[224:227], v[116:119]
    v_mul_f32 v108, v6, v108
    v_mul_f32 v109, v6, v109
    v_mul_f32 v110, v6, v110
    v_mfma_f32_16x16x32_bf16 v[120:123], v[136:139], v[236:239], v[120:123]
    v_mul_f32 v111, v6, v111
    v_cvt_pk_bf16_f32 v188, v96, v97
    v_cvt_pk_bf16_f32 v189, v98, v99
    s_waitcnt lgkmcnt(0)
    v_mfma_f32_16x16x32_bf16 v[132:135], v[140:143], v[236:239], v[132:135]
    v_cvt_pk_bf16_f32 v190, v108, v109
    v_cvt_pk_bf16_f32 v191, v110, v111
    buffer_store_dwordx4 v[188:191], v36, s[28:31], s82 offen offset:2048 sc1
    v_mfma_f32_16x16x32_bf16 v[128:131], v[140:143], v[224:227], v[128:131]
    v_mfma_f32_16x16x32_bf16 v[124:127], v[140:143], v[212:215], v[124:127]
    v_mul_f32 v112, v2, v112
    v_mul_f32 v113, v2, v113
    v_mul_f32 v114, v2, v114
    v_mul_f32 v115, v2, v115
    s_nop 3
    v_mul_f32 v124, v2, v124
    v_mul_f32 v125, v2, v125
    v_mul_f32 v126, v2, v126
    v_mul_f32 v127, v2, v127
    v_cvt_pk_bf16_f32 v192, v112, v113
    v_cvt_pk_bf16_f32 v193, v114, v115
    v_cvt_pk_bf16_f32 v194, v124, v125
    v_cvt_pk_bf16_f32 v195, v126, v127
    buffer_store_dwordx4 v[192:195], v36, s[28:31], 0 offen offset:3072 sc1
    v_mul_f32 v116, v4, v116
    v_mul_f32 v117, v4, v117
    v_mul_f32 v118, v4, v118
    v_mul_f32 v119, v4, v119
    v_mul_f32 v128, v4, v128
    v_mul_f32 v129, v4, v129
    v_mul_f32 v130, v4, v130
    v_mul_f32 v131, v4, v131
    v_cvt_pk_bf16_f32 v196, v116, v117
    v_cvt_pk_bf16_f32 v197, v118, v119
    v_cvt_pk_bf16_f32 v198, v128, v129
    v_cvt_pk_bf16_f32 v199, v130, v131
    buffer_store_dwordx4 v[196:199], v36, s[28:31], s81 offen offset:3072 sc1
    v_mul_f32 v120, v6, v120
    v_mul_f32 v121, v6, v121
    v_mul_f32 v122, v6, v122
    v_mul_f32 v123, v6, v123
    v_mul_f32 v132, v6, v132
    v_mul_f32 v133, v6, v133
    v_mul_f32 v134, v6, v134
    v_mul_f32 v135, v6, v135
    v_cvt_pk_bf16_f32 v200, v120, v121
    v_cvt_pk_bf16_f32 v201, v122, v123
    v_cvt_pk_bf16_f32 v202, v132, v133
    v_cvt_pk_bf16_f32 v203, v134, v135
    buffer_store_dwordx4 v[200:203], v36, s[28:31], s82 offen offset:3072 sc1
    s_cmp_lt_u32 s86, 30
    s_cbranch_scc1 L_tile
    v_mov_b32 v8, 1
    v_lshlrev_b32 v6, 24, v0
    v_lshlrev_b32 v7, 5, v0
    s_mov_b64 exec, 7
    s_waitcnt vmcnt(0)
    buffer_store_dword v8, v7, s[64:67], s93 offen
    buffer_store_dword v8, v6, s[64:67], s92 offen sc1
    s_mov_b64 exec, -1
    s_branch L_done
L_tile:
    s_barrier
L_common:
    v_lshrrev_b32 v3, 2, v0
    v_and_b32 v4, 7, v3
    v_lshlrev_b32 v4, 5, v4
    v_lshlrev_b32 v3, 8, v3
    v_add_u32 v3, v3, v4
    v_and_b32 v4, 3, v0
    v_lshlrev_b32 v4, 3, v4
    v_add_u32 v37, v3, v4
    s_lshl_b32 s24, s23, 5
    v_xor_b32 v10, s24, v37
    v_add_u32 v11, 65536, v10
    v_add_u32 v12, 131072, v10
    ds_read_b64_tr_b16 v[40:41], v11 offset:16384
    ds_read_b64_tr_b16 v[42:43], v11 offset:20480
    ds_read_b64_tr_b16 v[44:45], v11 offset:24576
    ds_read_b64_tr_b16 v[46:47], v11 offset:28672
    ds_read_b64_tr_b16 v[48:49], v10 offset:49152
    ds_read_b64_tr_b16 v[50:51], v10 offset:53248
    ds_read_b64_tr_b16 v[52:53], v10 offset:57344
    ds_read_b64_tr_b16 v[54:55], v10 offset:61440
    ds_read_b64_tr_b16 v[56:57], v11
    ds_read_b64_tr_b16 v[58:59], v11 offset:4096
    ds_read_b64_tr_b16 v[60:61], v11 offset:8192
    ds_read_b64_tr_b16 v[62:63], v11 offset:12288
    ds_read_b64_tr_b16 v[64:65], v11 offset:32768
    ds_read_b64_tr_b16 v[66:67], v11 offset:36864
    ds_read_b64_tr_b16 v[68:69], v11 offset:40960
    ds_read_b64_tr_b16 v[70:71], v11 offset:45056
    ds_read_b64_tr_b16 v[112:113], v11 offset:49152
    ds_read_b64_tr_b16 v[114:115], v11 offset:53248
    ds_read_b64_tr_b16 v[116:117], v11 offset:57344
    ds_read_b64_tr_b16 v[118:119], v11 offset:61440
    ds_read_b64_tr_b16 v[160:161], v12
    ds_read_b64_tr_b16 v[162:163], v12 offset:4096
    ds_read_b64_tr_b16 v[164:165], v12 offset:8192
    ds_read_b64_tr_b16 v[166:167], v12 offset:12288
    v_lshlrev_b32 v36, 4, v0
    v_add_u32 v14, 65536, v36
    v_add_u32 v15, 131072, v36
    v_lshrrev_b32 v2, 4, v0
    v_and_b32 v1, 15, v0
    s_lshl_b32 s26, s23, 2
    v_add_u32 v3, s26, v2
    v_and_b32 v4, 7, v3
    v_lshlrev_b32 v4, 1, v4
    v_xor_b32 v4, v4, v1
    v_lshlrev_b32 v4, 4, v4
    v_mul_u32_u24 v3, 1280, v3
    v_add_u32 v19, v3, v4
    v_and_b32 v3, 31, v0
    v_mul_u32_u24 v3, 2560, v3
    v_lshrrev_b32 v4, 5, v0
    v_lshl_add_u32 v38, v4, 4, v3
    s_lshl_b32 s90, s88, 1
    s_lshl_b32 s26, s83, 1
    s_lshr_b32 s24, s23, 2
    s_xor_b32 s24, s24, s26
    s_lshl_b32 s24, s24, 6
    s_and_b32 s25, s23, 3
    s_add_u32 s24, s24, s25
    s_lshl_b32 s81, s24, 11
    s_xor_b32 s26, s26, 6
    s_lshr_b32 s24, s23, 1
    s_xor_b32 s24, s24, s26
    s_lshl_b32 s24, s24, 6
    s_and_b32 s25, s23, 1
    s_add_u32 s24, s24, s25
    s_lshl_b32 s87, s24, 11
    s_mul_i32 s78, s83, 40960
    s_lshl_b32 s24, s95, 11
    s_add_u32 s87, s87, s24
    s_add_u32 s81, s81, s24
    s_lshl_b32 s24, s84, 3
    v_lshrrev_b32 v3, 3, v0
    v_xor_b32 v4, s26, v3
    v_add_u32 v4, s24, v4
    v_and_b32 v5, 7, v0
    v_lshl_add_u32 v6, v4, 3, v5
    s_lshl_b32 s26, s83, 11
    v_lshl_add_u32 v21, v6, 2, s26
    v_mul_u32_u24 v6, 86, v4
    v_lshrrev_b32 v6, 8, v6
    v_and_b32 v7, 3, v6
    v_lshrrev_b32 v6, 2, v6
    v_lshl_add_u32 v6, v6, 3, v5
    v_lshl_add_u32 v6, v6, 2, v7
    s_lshl_b32 s26, s83, 14
    v_lshl_add_u32 v22, v6, 7, s26
    v_and_b32 v3, 3, v0
    v_lshlrev_b32 v23, 14, v3
    v_lshl_add_u32 v9, v0, 24, s26
    v_mov_b32 v32, -1
    v_mov_b32 v33, -1
    v_mov_b32 v34, -1
    v_mov_b32 v35, -1
    s_cmp_ge_u32 s23, 4
    s_waitcnt vmcnt(0)
    s_cbranch_scc1 L_nopub
    v_mov_b32 v8, 1
    v_lshlrev_b32 v6, 24, v0
    v_lshlrev_b32 v7, 5, v0
    s_mov_b64 exec, 7
    s_waitcnt vmcnt(0)
    buffer_store_dword v8, v7, s[64:67], s93 offen
    buffer_store_dword v8, v6, s[64:67], s92 offen sc1
    s_mov_b64 exec, -1
L_nopub:
    v_mov_b32 v8, 1
    s_waitcnt lgkmcnt(0)
    s_barrier
    s_add_u32 m0, s88, 81920
    s_add_u32 s24, s95, 7
    s_and_b32 s24, s24, 15
    s_mul_i32 s27, s24, 81920
    s_add_u32 s24, s27, 0
    buffer_load_dwordx4 v19, s[48:51], s24 offen lds
    s_add_u32 m0, s88, 90112
    s_add_u32 s24, s27, 40960
    buffer_load_dwordx4 v19, s[48:51], s24 offen lds
    s_add_u32 m0, s88, 49152
    s_add_u32 s24, s95, 8
    s_and_b32 s24, s24, 15
    s_mul_i32 s27, s24, 81920
    s_add_u32 s24, s27, 0
    buffer_load_dwordx4 v19, s[48:51], s24 offen lds
    s_add_u32 m0, s88, 57344
    s_add_u32 s24, s27, 40960
    buffer_load_dwordx4 v19, s[48:51], s24 offen lds
    ds_read_b64_tr_b16 v[72:73], v10
    ds_read_b64_tr_b16 v[74:75], v10 offset:4096
    ds_read_b64_tr_b16 v[76:77], v10 offset:8192
    ds_read_b64_tr_b16 v[78:79], v10 offset:12288
    ds_read_b64_tr_b16 v[80:81], v10 offset:16384
    ds_read_b64_tr_b16 v[82:83], v10 offset:20480
    ds_read_b64_tr_b16 v[84:85], v10 offset:24576
    ds_read_b64_tr_b16 v[86:87], v10 offset:28672
    ds_read_b64_tr_b16 v[88:89], v10 offset:32768
    ds_read_b64_tr_b16 v[90:91], v10 offset:36864
    ds_read_b64_tr_b16 v[92:93], v10 offset:40960
    ds_read_b64_tr_b16 v[94:95], v10 offset:45056
L_flag1:
    buffer_load_dword v26, v21, s[64:67], s91 offen sc1
    s_add_u32 s98, s98, 0x2000
    s_cbranch_scc1 L_done
    s_waitcnt vmcnt(0)
    v_cmp_ne_u32 vcc, 1, v26
    s_nop 0
    s_and_b32 s24, vcc_lo, 4294967295
    s_cbranch_scc0 L_flag1_ok
    s_and_b32 s24, s98, 0xe000
    s_cbranch_scc1 L_flag1
    buffer_load_dword v26, v22, s[64:67], 0 offen sc1
    s_waitcnt vmcnt(0)
    v_cmp_ne_u32 vcc, 1, v26
    s_nop 0
    s_and_b32 s24, vcc_lo, 4294967295
    s_cbranch_scc1 L_flag1
L_flag1_ok:
    s_add_u32 m0, s90, 65536
    s_add_u32 s89, s87, 0
    s_andn2_b32 s89, s89, 0x18000
    buffer_load_dwordx4 v36, s[44:47], s89 offen sc1 lds
    buffer_load_dwordx4 v36, s[44:47], s89 offen offset:1024 sc1 lds
    s_waitcnt lgkmcnt(0)
    s_barrier
    s_add_u32 m0, s90, 98304
    s_add_u32 s89, s87, 4096
    s_andn2_b32 s89, s89, 0x18000
    buffer_load_dwordx4 v36, s[44:47], s89 offen sc1 lds
    buffer_load_dwordx4 v36, s[44:47], s89 offen offset:1024 sc1 lds
    s_add_u32 m0, s88, 114688
    s_add_u32 s24, s95, 10
    s_and_b32 s24, s24, 15
    s_mul_i32 s27, s24, 81920
    s_add_u32 s24, s27, 0
    buffer_load_dwordx4 v19, s[48:51], s24 offen lds
    s_add_u32 m0, s88, 122880
    s_add_u32 s24, s27, 40960
    buffer_load_dwordx4 v19, s[48:51], s24 offen lds
    ds_read_b64_tr_b16 v[96:97], v11 offset:16384
    ds_read_b64_tr_b16 v[98:99], v11 offset:20480
    ds_read_b64_tr_b16 v[100:101], v11 offset:24576
    ds_read_b64_tr_b16 v[102:103], v11 offset:28672
    ds_read_b64_tr_b16 v[104:105], v10 offset:49152
    ds_read_b64_tr_b16 v[106:107], v10 offset:53248
    ds_read_b64_tr_b16 v[108:109], v10 offset:57344
    ds_read_b64_tr_b16 v[110:111], v10 offset:61440
    s_waitcnt vmcnt(4)
    s_waitcnt lgkmcnt(0)
    s_barrier
    ds_read_b128 v[172:175], v14 offset:4096
    ds_read_b128 v[168:171], v14
    ds_read_b128 v[180:183], v14 offset:12288
    ds_read_b128 v[176:179], v14 offset:8192
    ds_read_b128 v[188:191], v14 offset:5120
    ds_read_b128 v[184:187], v14 offset:1024
    ds_read_b128 v[196:199], v14 offset:13312
    ds_read_b128 v[192:195], v14 offset:9216
    s_cmp_ge_u32 s23, 4
    s_cbranch_scc1 L_young
    s_setprio 0
    s_add_u32 m0, s90, 131072
    s_add_u32 s89, s87, 8192
    s_andn2_b32 s89, s89, 0x18000
    buffer_load_dwordx4 v36, s[44:47], s89 offen sc1 lds
    buffer_load_dwordx4 v36, s[44:47], s89 offen offset:1024 sc1 lds
    s_waitcnt lgkmcnt(6)
    v_mfma_f32_16x16x32_bf16 v[232:235], v[40:43], v[168:171], 0
    ds_read_b128 v[204:207], v14 offset:6144
    v_mfma_f32_16x16x32_bf16 v[236:239], v[40:43], v[172:175], 0
    ds_read_b128 v[200:203], v14 offset:2048
    s_waitcnt lgkmcnt(6)
    v_mfma_f32_16x16x32_bf16 v[240:243], v[40:43], v[176:179], 0
    ds_read_b128 v[212:215], v14 offset:14336
    v_mfma_f32_16x16x32_bf16 v[244:247], v[40:43], v[180:183], 0
    ds_read_b128 v[208:211], v14 offset:10240
    s_waitcnt lgkmcnt(6)
    v_mfma_f32_16x16x32_bf16 v[232:235], v[44:47], v[184:187], v[232:235]
    ds_read_b128 v[220:223], v14 offset:7168
    v_mfma_f32_16x16x32_bf16 v[236:239], v[44:47], v[188:191], v[236:239]
    ds_read_b128 v[216:219], v14 offset:3072
    s_waitcnt lgkmcnt(6)
    v_mfma_f32_16x16x32_bf16 v[240:243], v[44:47], v[192:195], v[240:243]
    ds_read_b128 v[228:231], v14 offset:15360
    v_mfma_f32_16x16x32_bf16 v[244:247], v[44:47], v[196:199], v[244:247]
    ds_read_b128 v[224:227], v14 offset:11264
    s_waitcnt vmcnt(4)
    s_barrier
    s_waitcnt lgkmcnt(6)
    v_mfma_f32_16x16x32_bf16 v[232:235], v[48:51], v[200:203], v[232:235]
    ds_read_b128 v[172:175], v14 offset:36864
    v_mfma_f32_16x16x32_bf16 v[236:239], v[48:51], v[204:207], v[236:239]
    ds_read_b128 v[168:171], v14 offset:32768
    s_waitcnt lgkmcnt(6)
    v_mfma_f32_16x16x32_bf16 v[240:243], v[48:51], v[208:211], v[240:243]
    ds_read_b128 v[180:183], v14 offset:45056
    v_mfma_f32_16x16x32_bf16 v[244:247], v[48:51], v[212:215], v[244:247]
    ds_read_b128 v[176:179], v14 offset:40960
    s_waitcnt lgkmcnt(6)
    v_mfma_f32_16x16x32_bf16 v[232:235], v[52:55], v[216:219], v[232:235]
    ds_read_b128 v[188:191], v14 offset:37888
    v_mfma_f32_16x16x32_bf16 v[236:239], v[52:55], v[220:223], v[236:239]
    ds_read_b128 v[184:187], v14 offset:33792
    s_waitcnt lgkmcnt(6)
    v_mfma_f32_16x16x32_bf16 v[240:243], v[52:55], v[224:227], v[240:243]
    ds_read_b128 v[196:199], v14 offset:46080
    v_mfma_f32_16x16x32_bf16 v[244:247], v[52:55], v[228:231], v[244:247]
    ds_read_b128 v[192:195], v14 offset:41984
    s_waitcnt lgkmcnt(6)
    v_mfma_f32_16x16x32_bf16 v[232:235], v[56:59], v[168:171], v[232:235]
    ds_read_b128 v[204:207], v14 offset:38912
    v_mfma_f32_16x16x32_bf16 v[236:239], v[56:59], v[172:175], v[236:239]
    ds_read_b128 v[200:203], v14 offset:34816
    s_waitcnt lgkmcnt(6)
    v_mfma_f32_16x16x32_bf16 v[240:243], v[56:59], v[176:179], v[240:243]
    ds_read_b128 v[212:215], v14 offset:47104
    v_mfma_f32_16x16x32_bf16 v[244:247], v[56:59], v[180:183], v[244:247]
    ds_read_b128 v[208:211], v14 offset:43008
    s_waitcnt lgkmcnt(6)
    v_mfma_f32_16x16x32_bf16 v[232:235], v[60:63], v[184:187], v[232:235]
    ds_read_b128 v[220:223], v14 offset:39936
    v_mfma_f32_16x16x32_bf16 v[236:239], v[60:63], v[188:191], v[236:239]
    ds_read_b128 v[216:219], v14 offset:35840
    s_waitcnt lgkmcnt(6)
    v_mfma_f32_16x16x32_bf16 v[240:243], v[60:63], v[192:195], v[240:243]
    ds_read_b128 v[228:231], v14 offset:48128
    v_mfma_f32_16x16x32_bf16 v[244:247], v[60:63], v[196:199], v[244:247]
    ds_read_b128 v[224:227], v14 offset:44032
    s_add_u32 m0, s88, 147456
    s_add_u32 s24, s95, 11
    s_and_b32 s24, s24, 15
    s_mul_i32 s27, s24, 81920
    s_add_u32 s24, s27, 0
    buffer_load_dwordx4 v19, s[48:51], s24 offen lds
    s_add_u32 m0, s88, 155648
    s_add_u32 s24, s27, 40960
    buffer_load_dwordx4 v19, s[48:51], s24 offen lds
    s_add_u32 m0, s90, 0
    s_add_u32 s89, s87, 12288
    s_andn2_b32 s89, s89, 0x18000
    buffer_load_dwordx4 v36, s[44:47], s89 offen sc1 lds
    buffer_load_dwordx4 v36, s[44:47], s89 offen offset:1024 sc1 lds
    s_waitcnt vmcnt(4)
    s_barrier
    s_waitcnt lgkmcnt(6)
    v_mfma_f32_16x16x32_bf16 v[232:235], v[64:67], v[200:203], v[232:235]
    ds_read_b128 v[172:175], v15 offset:4096
    ds_read_b64_tr_b16 v[120:121], v11 offset:49152
    v_mfma_f32_16x16x32_bf16 v[236:239], v[64:67], v[204:207], v[236:239]
    ds_read_b128 v[168:171], v15
    s_waitcnt lgkmcnt(7)
    v_mfma_f32_16x16x32_bf16 v[240:243], v[64:67], v[208:211], v[240:243]
    ds_read_b128 v[180:183], v15 offset:12288
    ds_read_b64_tr_b16 v[122:123], v11 offset:53248
    v_mfma_f32_16x16x32_bf16 v[244:247], v[64:67], v[212:215], v[244:247]
    ds_read_b128 v[176:179], v15 offset:8192
    s_waitcnt lgkmcnt(8)
    v_mfma_f32_16x16x32_bf16 v[232:235], v[68:71], v[216:219], v[232:235]
    ds_read_b128 v[188:191], v15 offset:5120
    ds_read_b64_tr_b16 v[124:125], v11 offset:57344
    v_mfma_f32_16x16x32_bf16 v[236:239], v[68:71], v[220:223], v[236:239]
    ds_read_b128 v[184:187], v15 offset:1024
    s_waitcnt lgkmcnt(9)
    v_mfma_f32_16x16x32_bf16 v[240:243], v[68:71], v[224:227], v[240:243]
    ds_read_b128 v[196:199], v15 offset:13312
    ds_read_b64_tr_b16 v[126:127], v11 offset:61440
    v_mfma_f32_16x16x32_bf16 v[244:247], v[68:71], v[228:231], v[244:247]
    ds_read_b128 v[192:195], v15 offset:9216
    s_waitcnt lgkmcnt(9)
    v_mfma_f32_16x16x32_bf16 v[232:235], v[72:75], v[168:171], v[232:235]
    ds_read_b128 v[204:207], v15 offset:6144
    v_mfma_f32_16x16x32_bf16 v[236:239], v[72:75], v[172:175], v[236:239]
    ds_read_b128 v[200:203], v15 offset:2048
    s_waitcnt lgkmcnt(8)
    v_mfma_f32_16x16x32_bf16 v[240:243], v[72:75], v[176:179], v[240:243]
    ds_read_b128 v[212:215], v15 offset:14336
    v_mfma_f32_16x16x32_bf16 v[244:247], v[72:75], v[180:183], v[244:247]
    ds_read_b128 v[208:211], v15 offset:10240
    s_waitcnt lgkmcnt(7)
    v_mfma_f32_16x16x32_bf16 v[232:235], v[76:79], v[184:187], v[232:235]
    ds_read_b128 v[220:223], v15 offset:7168
    v_mfma_f32_16x16x32_bf16 v[236:239], v[76:79], v[188:191], v[236:239]
    ds_read_b128 v[216:219], v15 offset:3072
    s_waitcnt lgkmcnt(6)
    v_mfma_f32_16x16x32_bf16 v[240:243], v[76:79], v[192:195], v[240:243]
    ds_read_b128 v[228:231], v15 offset:15360
    v_mfma_f32_16x16x32_bf16 v[244:247], v[76:79], v[196:199], v[244:247]
    ds_read_b128 v[224:227], v15 offset:11264
    s_add_u32 m0, s88, 16384
    s_add_u32 s24, s95, 12
    s_and_b32 s24, s24, 15
    s_mul_i32 s27, s24, 81920
    s_add_u32 s24, s27, 0
    buffer_load_dwordx4 v19, s[48:51], s24 offen lds
    s_add_u32 m0, s88, 24576
    s_add_u32 s24, s27, 40960
    buffer_load_dwordx4 v19, s[48:51], s24 offen lds
    s_add_u32 m0, s90, 32768
    s_add_u32 s89, s87, 16384
    s_andn2_b32 s89, s89, 0x18000
    buffer_load_dwordx4 v36, s[44:47], s89 offen sc1 lds
    buffer_load_dwordx4 v36, s[44:47], s89 offen offset:1024 sc1 lds
    s_waitcnt vmcnt(4)
    s_barrier
    s_waitcnt lgkmcnt(6)
    v_mfma_f32_16x16x32_bf16 v[232:235], v[80:83], v[200:203], v[232:235]
    ds_read_b128 v[172:175], v36 offset:4096
    ds_read_b64_tr_b16 v[128:129], v12 offset:16384
    v_mfma_f32_16x16x32_bf16 v[236:239], v[80:83], v[204:207], v[236:239]
    ds_read_b128 v[168:171], v36
    s_waitcnt lgkmcnt(7)
    v_mfma_f32_16x16x32_bf16 v[240:243], v[80:83], v[208:211], v[240:243]
    ds_read_b128 v[180:183], v36 offset:12288
    ds_read_b64_tr_b16 v[130:131], v12 offset:20480
    v_mfma_f32_16x16x32_bf16 v[244:247], v[80:83], v[212:215], v[244:247]
    ds_read_b128 v[176:179], v36 offset:8192
    s_waitcnt lgkmcnt(8)
    v_mfma_f32_16x16x32_bf16 v[232:235], v[84:87], v[216:219], v[232:235]
    ds_read_b128 v[188:191], v36 offset:5120
    ds_read_b64_tr_b16 v[132:133], v12 offset:24576
    v_mfma_f32_16x16x32_bf16 v[236:239], v[84:87], v[220:223], v[236:239]
    ds_read_b128 v[184:187], v36 offset:1024
    s_waitcnt lgkmcnt(9)
    v_mfma_f32_16x16x32_bf16 v[240:243], v[84:87], v[224:227], v[240:243]
    ds_read_b128 v[196:199], v36 offset:13312
    ds_read_b64_tr_b16 v[134:135], v12 offset:28672
    v_mfma_f32_16x16x32_bf16 v[244:247], v[84:87], v[228:231], v[244:247]
    ds_read_b128 v[192:195], v36 offset:9216
    s_waitcnt lgkmcnt(9)
    v_mfma_f32_16x16x32_bf16 v[232:235], v[88:91], v[168:171], v[232:235]
    ds_read_b128 v[204:207], v36 offset:6144
    v_mfma_f32_16x16x32_bf16 v[236:239], v[88:91], v[172:175], v[236:239]
    ds_read_b128 v[200:203], v36 offset:2048
    s_waitcnt lgkmcnt(8)
    v_mfma_f32_16x16x32_bf16 v[240:243], v[88:91], v[176:179], v[240:243]
    ds_read_b128 v[212:215], v36 offset:14336
    v_mfma_f32_16x16x32_bf16 v[244:247], v[88:91], v[180:183], v[244:247]
    ds_read_b128 v[208:211], v36 offset:10240
    s_waitcnt lgkmcnt(7)
    v_mfma_f32_16x16x32_bf16 v[232:235], v[92:95], v[184:187], v[232:235]
    ds_read_b128 v[220:223], v36 offset:7168
    v_mfma_f32_16x16x32_bf16 v[236:239], v[92:95], v[188:191], v[236:239]
    ds_read_b128 v[216:219], v36 offset:3072
    s_waitcnt lgkmcnt(6)
    v_mfma_f32_16x16x32_bf16 v[240:243], v[92:95], v[192:195], v[240:243]
    ds_read_b128 v[228:231], v36 offset:15360
    v_mfma_f32_16x16x32_bf16 v[244:247], v[92:95], v[196:199], v[244:247]
    ds_read_b128 v[224:227], v36 offset:11264
    s_add_u32 m0, s88, 81920
    s_add_u32 s24, s95, 13
    s_and_b32 s24, s24, 15
    s_mul_i32 s27, s24, 81920
    s_add_u32 s24, s27, 0
    buffer_load_dwordx4 v19, s[48:51], s24 offen lds
    s_add_u32 m0, s88, 90112
    s_add_u32 s24, s27, 40960
    buffer_load_dwordx4 v19, s[48:51], s24 offen lds
    s_add_u32 m0, s90, 49152
    s_add_u32 s89, s87, 20480
    s_andn2_b32 s89, s89, 0x18000
    buffer_load_dwordx4 v36, s[44:47], s89 offen sc1 lds
    buffer_load_dwordx4 v36, s[44:47], s89 offen offset:1024 sc1 lds
    s_waitcnt vmcnt(4)
    s_barrier
    s_waitcnt lgkmcnt(6)
    v_mfma_f32_16x16x32_bf16 v[232:235], v[96:99], v[200:203], v[232:235]
    ds_read_b128 v[172:175], v36 offset:36864
    ds_read_b64_tr_b16 v[136:137], v10 offset:16384
    v_mfma_f32_16x16x32_bf16 v[236:239], v[96:99], v[204:207], v[236:239]
    ds_read_b128 v[168:171], v36 offset:32768
    s_waitcnt lgkmcnt(7)
    v_mfma_f32_16x16x32_bf16 v[240:243], v[96:99], v[208:211], v[240:243]
    ds_read_b128 v[180:183], v36 offset:45056
    ds_read_b64_tr_b16 v[138:139], v10 offset:20480
    v_mfma_f32_16x16x32_bf16 v[244:247], v[96:99], v[212:215], v[244:247]
    ds_read_b128 v[176:179], v36 offset:40960
    s_waitcnt lgkmcnt(8)
    v_mfma_f32_16x16x32_bf16 v[232:235], v[100:103], v[216:219], v[232:235]
    ds_read_b128 v[188:191], v36 offset:37888
    ds_read_b64_tr_b16 v[140:141], v10 offset:24576
    v_mfma_f32_16x16x32_bf16 v[236:239], v[100:103], v[220:223], v[236:239]
    ds_read_b128 v[184:187], v36 offset:33792
    s_waitcnt lgkmcnt(9)
    v_mfma_f32_16x16x32_bf16 v[240:243], v[100:103], v[224:227], v[240:243]
    ds_read_b128 v[196:199], v36 offset:46080
    ds_read_b64_tr_b16 v[142:143], v10 offset:28672
    v_mfma_f32_16x16x32_bf16 v[244:247], v[100:103], v[228:231], v[244:247]
    ds_read_b128 v[192:195], v36 offset:41984
    s_waitcnt lgkmcnt(9)
    v_mfma_f32_16x16x32_bf16 v[232:235], v[104:107], v[168:171], v[232:235]
    ds_read_b128 v[204:207], v36 offset:38912
    v_mfma_f32_16x16x32_bf16 v[236:239], v[104:107], v[172:175], v[236:239]
    ds_read_b128 v[200:203], v36 offset:34816
    s_waitcnt lgkmcnt(8)
    v_mfma_f32_16x16x32_bf16 v[240:243], v[104:107], v[176:179], v[240:243]
    ds_read_b128 v[212:215], v36 offset:47104
    v_mfma_f32_16x16x32_bf16 v[244:247], v[104:107], v[180:183], v[244:247]
    ds_read_b128 v[208:211], v36 offset:43008
    s_waitcnt lgkmcnt(7)
    v_mfma_f32_16x16x32_bf16 v[232:235], v[108:111], v[184:187], v[232:235]
    ds_read_b128 v[220:223], v36 offset:39936
    v_mfma_f32_16x16x32_bf16 v[236:239], v[108:111], v[188:191], v[236:239]
    ds_read_b128 v[216:219], v36 offset:35840
    s_waitcnt lgkmcnt(6)
    v_mfma_f32_16x16x32_bf16 v[240:243], v[108:111], v[192:195], v[240:243]
    ds_read_b128 v[228:231], v36 offset:48128
    v_mfma_f32_16x16x32_bf16 v[244:247], v[108:111], v[196:199], v[244:247]
    ds_read_b128 v[224:227], v36 offset:44032
    s_add_u32 m0, s88, 65536
    s_add_u32 s24, s95, 14
    s_and_b32 s24, s24, 15
    s_mul_i32 s27, s24, 81920
    s_add_u32 s24, s27, 0
    buffer_load_dwordx4 v19, s[48:51], s24 offen lds
    s_add_u32 m0, s88, 73728
    s_add_u32 s24, s27, 40960
    buffer_load_dwordx4 v19, s[48:51], s24 offen lds
    buffer_load_dword v26, v21, s[64:67], s91 offen sc1
    s_add_u32 m0, s90, 98304
    s_add_u32 s89, s87, 24576
    s_andn2_b32 s89, s89, 0x18000
    buffer_load_dwordx4 v36, s[44:47], s89 offen sc1 lds
    buffer_load_dwordx4 v36, s[44:47], s89 offen offset:1024 sc1 lds
    s_waitcnt vmcnt(5)
    s_barrier
    s_waitcnt lgkmcnt(6)
    v_mfma_f32_16x16x32_bf16 v[232:235], v[112:115], v[200:203], v[232:235]
    ds_read_b128 v[172:175], v36 offset:53248
    ds_read_b64_tr_b16 v[144:145], v11 offset:16384
    v_mfma_f32_16x16x32_bf16 v[236:239], v[112:115], v[204:207], v[236:239]
    ds_read_b128 v[168:171], v36 offset:49152
    s_waitcnt lgkmcnt(7)
    v_mfma_f32_16x16x32_bf16 v[240:243], v[112:115], v[208:211], v[240:243]
    ds_read_b128 v[180:183], v36 offset:61440
    ds_read_b64_tr_b16 v[146:147], v11 offset:20480
    v_mfma_f32_16x16x32_bf16 v[244:247], v[112:115], v[212:215], v[244:247]
    ds_read_b128 v[176:179], v36 offset:57344
    s_waitcnt lgkmcnt(8)
    v_mfma_f32_16x16x32_bf16 v[232:235], v[116:119], v[216:219], v[232:235]
    ds_read_b128 v[188:191], v36 offset:54272
    ds_read_b64_tr_b16 v[148:149], v11 offset:24576
    v_mfma_f32_16x16x32_bf16 v[236:239], v[116:119], v[220:223], v[236:239]
    ds_read_b128 v[184:187], v36 offset:50176
    s_waitcnt lgkmcnt(9)
    v_mfma_f32_16x16x32_bf16 v[240:243], v[116:119], v[224:227], v[240:243]
    ds_read_b128 v[196:199], v36 offset:62464
    ds_read_b64_tr_b16 v[150:151], v11 offset:28672
    v_mfma_f32_16x16x32_bf16 v[244:247], v[116:119], v[228:231], v[244:247]
    ds_read_b128 v[192:195], v36 offset:58368
    s_waitcnt lgkmcnt(9)
    v_mfma_f32_16x16x32_bf16 v[232:235], v[120:123], v[168:171], v[232:235]
    ds_read_b128 v[204:207], v36 offset:55296
    v_mfma_f32_16x16x32_bf16 v[236:239], v[120:123], v[172:175], v[236:239]
    ds_read_b128 v[200:203], v36 offset:51200
    s_waitcnt lgkmcnt(8)
    v_mfma_f32_16x16x32_bf16 v[240:243], v[120:123], v[176:179], v[240:243]
    ds_read_b128 v[212:215], v36 offset:63488
    v_mfma_f32_16x16x32_bf16 v[244:247], v[120:123], v[180:183], v[244:247]
    ds_read_b128 v[208:211], v36 offset:59392
    s_waitcnt lgkmcnt(7)
    v_mfma_f32_16x16x32_bf16 v[232:235], v[124:127], v[184:187], v[232:235]
    ds_read_b128 v[220:223], v36 offset:56320
    v_mfma_f32_16x16x32_bf16 v[236:239], v[124:127], v[188:191], v[236:239]
    ds_read_b128 v[216:219], v36 offset:52224
    s_waitcnt lgkmcnt(6)
    v_mfma_f32_16x16x32_bf16 v[240:243], v[124:127], v[192:195], v[240:243]
    ds_read_b128 v[228:231], v36 offset:64512
    v_mfma_f32_16x16x32_bf16 v[244:247], v[124:127], v[196:199], v[244:247]
    ds_read_b128 v[224:227], v36 offset:60416
L_pad6:
    s_cbranch_execz L_walked
    s_add_u32 m0, s90, 114688
    s_add_u32 s89, s87, 28672
    s_andn2_b32 s89, s89, 0x18000
    buffer_load_dwordx4 v36, s[44:47], s89 offen sc1 lds
    buffer_load_dwordx4 v36, s[44:47], s89 offen offset:1024 sc1 lds
    s_waitcnt vmcnt(4)
    v_cmp_ne_u32 vcc, 1, v26
    s_cbranch_vccz L_resta_ok
L_resta:
    buffer_load_dword v26, v21, s[64:67], s91 offen sc1
    s_add_u32 s98, s98, 0x2000
    s_cbranch_scc1 L_done
    s_waitcnt vmcnt(0)
    v_cmp_ne_u32 vcc, 1, v26
    s_cbranch_vccz L_resta_ok
    s_and_b32 s24, s98, 0xe000
    s_cbranch_scc1 L_resta
    buffer_load_dword v26, v22, s[64:67], 0 offen sc1
    s_waitcnt vmcnt(0)
    v_cmp_ne_u32 vcc, 1, v26
    s_cbranch_vccnz L_resta
L_resta_ok:
    s_add_u32 m0, s90, 131072
    s_add_u32 s89, s81, 0
    s_andn2_b32 s89, s89, 0x18000
    s_xor_b32 s89, s89, 262144
    buffer_load_dwordx4 v36, s[44:47], s89 offen sc1 lds
    buffer_load_dwordx4 v36, s[44:47], s89 offen offset:1024 sc1 lds
    s_waitcnt vmcnt(4)
    s_barrier
    s_waitcnt lgkmcnt(6)
    v_mfma_f32_16x16x32_bf16 v[232:235], v[128:131], v[200:203], v[232:235]
    ds_read_b128 v[172:175], v14 offset:36864
    ds_read_b64_tr_b16 v[152:153], v11
    v_mfma_f32_16x16x32_bf16 v[236:239], v[128:131], v[204:207], v[236:239]
    ds_read_b128 v[168:171], v14 offset:32768
    s_waitcnt lgkmcnt(7)
    v_mfma_f32_16x16x32_bf16 v[240:243], v[128:131], v[208:211], v[240:243]
    ds_read_b128 v[180:183], v14 offset:45056
    ds_read_b64_tr_b16 v[154:155], v11 offset:4096
    v_mfma_f32_16x16x32_bf16 v[244:247], v[128:131], v[212:215], v[244:247]
    ds_read_b128 v[176:179], v14 offset:40960
    s_waitcnt lgkmcnt(8)
    v_mfma_f32_16x16x32_bf16 v[232:235], v[132:135], v[216:219], v[232:235]
    ds_read_b128 v[188:191], v14 offset:37888
    ds_read_b64_tr_b16 v[156:157], v11 offset:8192
    v_mfma_f32_16x16x32_bf16 v[236:239], v[132:135], v[220:223], v[236:239]
    ds_read_b128 v[184:187], v14 offset:33792
    s_waitcnt lgkmcnt(9)
    v_mfma_f32_16x16x32_bf16 v[240:243], v[132:135], v[224:227], v[240:243]
    ds_read_b128 v[196:199], v14 offset:46080
    ds_read_b64_tr_b16 v[158:159], v11 offset:12288
    v_mfma_f32_16x16x32_bf16 v[244:247], v[132:135], v[228:231], v[244:247]
    ds_read_b128 v[192:195], v14 offset:41984
    s_waitcnt lgkmcnt(9)
    v_mfma_f32_16x16x32_bf16 v[232:235], v[136:139], v[168:171], v[232:235]
    ds_read_b128 v[204:207], v14 offset:38912
    v_mfma_f32_16x16x32_bf16 v[236:239], v[136:139], v[172:175], v[236:239]
    ds_read_b128 v[200:203], v14 offset:34816
    s_waitcnt lgkmcnt(8)
    v_mfma_f32_16x16x32_bf16 v[240:243], v[136:139], v[176:179], v[240:243]
    ds_read_b128 v[212:215], v14 offset:47104
    v_mfma_f32_16x16x32_bf16 v[244:247], v[136:139], v[180:183], v[244:247]
    ds_read_b128 v[208:211], v14 offset:43008
    s_add_u32 m0, s90, 147456
    s_add_u32 s89, s81, 8192
    s_andn2_b32 s89, s89, 0x18000
    s_xor_b32 s89, s89, 262144
    buffer_load_dwordx4 v36, s[44:47], s89 offen sc1 lds
    buffer_load_dwordx4 v36, s[44:47], s89 offen offset:1024 sc1 lds
    s_xor_b32 s82, s78, 32768
    buffer_store_dwordx4 v[32:35], v36, s[52:55], s82 offen sc1
    s_waitcnt vmcnt(5)
    s_barrier
    s_waitcnt lgkmcnt(7)
    v_mfma_f32_16x16x32_bf16 v[232:235], v[140:143], v[184:187], v[232:235]
    ds_read_b128 v[220:223], v14 offset:39936
    ds_read_b128 v[216:219], v14 offset:35840
    v_mfma_f32_16x16x32_bf16 v[236:239], v[140:143], v[188:191], v[236:239]
    ds_read_b128 v[228:231], v14 offset:48128
    ds_read_b128 v[224:227], v14 offset:44032
    s_waitcnt lgkmcnt(8)
    v_mfma_f32_16x16x32_bf16 v[240:243], v[140:143], v[192:195], v[240:243]
    ds_read_b128 v[172:175], v14 offset:53248
    ds_read_b128 v[168:171], v14 offset:49152
    v_mfma_f32_16x16x32_bf16 v[244:247], v[140:143], v[196:199], v[244:247]
    ds_read_b128 v[180:183], v14 offset:61440
    ds_read_b128 v[176:179], v14 offset:57344
    s_waitcnt lgkmcnt(10)
    v_mfma_f32_16x16x32_bf16 v[232:235], v[144:147], v[200:203], v[232:235]
    ds_read_b128 v[188:191], v14 offset:54272
    v_mfma_f32_16x16x32_bf16 v[236:239], v[144:147], v[204:207], v[236:239]
    ds_read_b128 v[184:187], v14 offset:50176
    s_waitcnt lgkmcnt(10)
    v_mfma_f32_16x16x32_bf16 v[240:243], v[144:147], v[208:211], v[240:243]
    ds_read_b128 v[196:199], v14 offset:62464
    v_mfma_f32_16x16x32_bf16 v[244:247], v[144:147], v[212:215], v[244:247]
    ds_read_b128 v[192:195], v14 offset:58368
    s_waitcnt lgkmcnt(10)
    v_mfma_f32_16x16x32_bf16 v[232:235], v[148:151], v[216:219], v[232:235]
    ds_read_b128 v[204:207], v14 offset:55296
    v_mfma_f32_16x16x32_bf16 v[236:239], v[148:151], v[220:223], v[236:239]
    ds_read_b128 v[200:203], v14 offset:51200
    s_waitcnt lgkmcnt(10)
    v_mfma_f32_16x16x32_bf16 v[240:243], v[148:151], v[224:227], v[240:243]
    ds_read_b128 v[212:215], v14 offset:63488
    v_mfma_f32_16x16x32_bf16 v[244:247], v[148:151], v[228:231], v[244:247]
    ds_read_b128 v[208:211], v14 offset:59392
    s_add_u32 m0, s90, 0
    s_add_u32 s89, s81, 16384
    s_andn2_b32 s89, s89, 0x18000
    s_xor_b32 s89, s89, 262144
    buffer_load_dwordx4 v36, s[44:47], s89 offen sc1 lds
    buffer_load_dwordx4 v36, s[44:47], s89 offen offset:1024 sc1 lds
    s_waitcnt vmcnt(5)
    s_barrier
    s_waitcnt lgkmcnt(10)
    v_mfma_f32_16x16x32_bf16 v[232:235], v[152:155], v[168:171], v[232:235]
    ds_read_b128 v[220:223], v14 offset:56320
    v_mfma_f32_16x16x32_bf16 v[236:239], v[152:155], v[172:175], v[236:239]
    ds_read_b128 v[216:219], v14 offset:52224
    s_waitcnt lgkmcnt(10)
    v_mfma_f32_16x16x32_bf16 v[240:243], v[152:155], v[176:179], v[240:243]
    ds_read_b128 v[228:231], v14 offset:64512
    v_mfma_f32_16x16x32_bf16 v[244:247], v[152:155], v[180:183], v[244:247]
    ds_read_b128 v[224:227], v14 offset:60416
    s_waitcnt lgkmcnt(10)
    v_mfma_f32_16x16x32_bf16 v[232:235], v[156:159], v[184:187], v[232:235]
    ds_read_b128 v[172:175], v15 offset:8192
    v_mfma_f32_16x16x32_bf16 v[236:239], v[156:159], v[188:191], v[236:239]
    ds_read_b128 v[168:171], v15
    s_waitcnt lgkmcnt(10)
    v_mfma_f32_16x16x32_bf16 v[240:243], v[156:159], v[192:195], v[240:243]
    ds_read_b128 v[180:183], v15 offset:9216
    v_mfma_f32_16x16x32_bf16 v[244:247], v[156:159], v[196:199], v[244:247]
    ds_read_b128 v[176:179], v15 offset:1024
    s_waitcnt lgkmcnt(10)
    v_mfma_f32_16x16x32_bf16 v[232:235], v[160:163], v[200:203], v[232:235]
    ds_read_b128 v[188:191], v15 offset:10240
    v_mfma_f32_16x16x32_bf16 v[236:239], v[160:163], v[204:207], v[236:239]
    ds_read_b128 v[184:187], v15 offset:2048
    s_waitcnt lgkmcnt(10)
    v_mfma_f32_16x16x32_bf16 v[240:243], v[160:163], v[208:211], v[240:243]
    ds_read_b128 v[196:199], v15 offset:11264
    v_mfma_f32_16x16x32_bf16 v[244:247], v[160:163], v[212:215], v[244:247]
    ds_read_b128 v[192:195], v15 offset:3072
    s_waitcnt lgkmcnt(10)
    v_mfma_f32_16x16x32_bf16 v[232:235], v[164:167], v[216:219], v[232:235]
    ds_read_b128 v[204:207], v15 offset:12288
    v_mfma_f32_16x16x32_bf16 v[236:239], v[164:167], v[220:223], v[236:239]
    ds_read_b128 v[200:203], v15 offset:4096
    s_waitcnt lgkmcnt(10)
    v_mfma_f32_16x16x32_bf16 v[240:243], v[164:167], v[224:227], v[240:243]
    ds_read_b128 v[212:215], v15 offset:13312
    v_mfma_f32_16x16x32_bf16 v[244:247], v[164:167], v[228:231], v[244:247]
    ds_read_b128 v[208:211], v15 offset:5120
    s_add_u32 m0, s90, 16384
    s_add_u32 s89, s81, 24576
    s_andn2_b32 s89, s89, 0x18000
    s_xor_b32 s89, s89, 262144
    buffer_load_dwordx4 v36, s[44:47], s89 offen sc1 lds
    buffer_load_dwordx4 v36, s[44:47], s89 offen offset:1024 sc1 lds
    v_cvt_pk_bf16_f32 v28, v232, v233
    v_cvt_pk_bf16_f32 v29, v234, v235
    v_cvt_pk_bf16_f32 v30, v236, v237
    v_cvt_pk_bf16_f32 v31, v238, v239
    s_xor_b32 s82, s78, 98304
    buffer_store_dwordx4 v[28:31], v36, s[52:55], s82 offen sc1
    s_nop 1
    v_cvt_pk_bf16_f32 v28, v240, v241
    v_cvt_pk_bf16_f32 v29, v242, v243
    v_cvt_pk_bf16_f32 v30, v244, v245
    v_cvt_pk_bf16_f32 v31, v246, v247
    s_xor_b32 s82, s78, 65536
    buffer_store_dwordx4 v[28:31], v36, s[52:55], s82 offen sc1
    s_waitcnt vmcnt(7)
    s_barrier
    s_waitcnt lgkmcnt(10)
    v_mfma_f32_16x16x32_bf16 v[232:235], v[40:43], v[168:171], 0
    ds_read_b128 v[220:223], v15 offset:14336
    v_mfma_f32_16x16x32_bf16 v[236:239], v[40:43], v[172:175], 0
    ds_read_b128 v[216:219], v15 offset:6144
    s_waitcnt lgkmcnt(10)
    v_mfma_f32_16x16x32_bf16 v[232:235], v[44:47], v[176:179], v[232:235]
    ds_read_b128 v[228:231], v15 offset:15360
    v_mfma_f32_16x16x32_bf16 v[236:239], v[44:47], v[180:183], v[236:239]
    ds_read_b128 v[224:227], v15 offset:7168
    s_waitcnt lgkmcnt(10)
    v_mfma_f32_16x16x32_bf16 v[232:235], v[48:51], v[184:187], v[232:235]
    ds_read_b128 v[172:175], v15 offset:24576
    v_mfma_f32_16x16x32_bf16 v[236:239], v[48:51], v[188:191], v[236:239]
    ds_read_b128 v[168:171], v15 offset:16384
    s_waitcnt lgkmcnt(10)
    v_mfma_f32_16x16x32_bf16 v[232:235], v[52:55], v[192:195], v[232:235]
    ds_read_b128 v[180:183], v15 offset:25600
    v_mfma_f32_16x16x32_bf16 v[236:239], v[52:55], v[196:199], v[236:239]
    ds_read_b128 v[176:179], v15 offset:17408
    s_waitcnt lgkmcnt(10)
    v_mfma_f32_16x16x32_bf16 v[232:235], v[56:59], v[200:203], v[232:235]
    ds_read_b128 v[188:191], v15 offset:26624
    v_mfma_f32_16x16x32_bf16 v[236:239], v[56:59], v[204:207], v[236:239]
    ds_read_b128 v[184:187], v15 offset:18432
    s_waitcnt lgkmcnt(10)
    v_mfma_f32_16x16x32_bf16 v[232:235], v[60:63], v[208:211], v[232:235]
    ds_read_b128 v[196:199], v15 offset:27648
    v_mfma_f32_16x16x32_bf16 v[236:239], v[60:63], v[212:215], v[236:239]
    ds_read_b128 v[192:195], v15 offset:19456
    s_waitcnt lgkmcnt(10)
    v_mfma_f32_16x16x32_bf16 v[232:235], v[64:67], v[216:219], v[232:235]
    ds_read_b128 v[204:207], v15 offset:28672
    v_mfma_f32_16x16x32_bf16 v[236:239], v[64:67], v[220:223], v[236:239]
    ds_read_b128 v[200:203], v15 offset:20480
    s_waitcnt lgkmcnt(10)
    v_mfma_f32_16x16x32_bf16 v[232:235], v[68:71], v[224:227], v[232:235]
    ds_read_b128 v[212:215], v15 offset:29696
    v_mfma_f32_16x16x32_bf16 v[236:239], v[68:71], v[228:231], v[236:239]
    ds_read_b128 v[208:211], v15 offset:21504
    s_add_u32 m0, s90, 32768
    s_add_u32 s89, s81, 0
    s_andn2_b32 s89, s89, 0x18000
    buffer_load_dwordx4 v36, s[44:47], s89 offen sc1 lds
    buffer_load_dwordx4 v36, s[44:47], s89 offen offset:1024 sc1 lds
    s_waitcnt vmcnt(6)
    s_barrier
    s_waitcnt lgkmcnt(10)
    v_mfma_f32_16x16x32_bf16 v[232:235], v[72:75], v[168:171], v[232:235]
    ds_read_b128 v[220:223], v15 offset:30720
    v_mfma_f32_16x16x32_bf16 v[236:239], v[72:75], v[172:175], v[236:239]
    ds_read_b128 v[216:219], v15 offset:22528
    s_waitcnt lgkmcnt(10)
    v_mfma_f32_16x16x32_bf16 v[232:235], v[76:79], v[176:179], v[232:235]
    ds_read_b128 v[228:231], v15 offset:31744
    v_mfma_f32_16x16x32_bf16 v[236:239], v[76:79], v[180:183], v[236:239]
    ds_read_b128 v[224:227], v15 offset:23552
    s_waitcnt lgkmcnt(10)
    v_mfma_f32_16x16x32_bf16 v[232:235], v[80:83], v[184:187], v[232:235]
    ds_read_b128 v[172:175], v36 offset:8192
    v_mfma_f32_16x16x32_bf16 v[236:239], v[80:83], v[188:191], v[236:239]
    ds_read_b128 v[168:171], v36
    s_waitcnt lgkmcnt(10)
    v_mfma_f32_16x16x32_bf16 v[232:235], v[84:87], v[192:195], v[232:235]
    ds_read_b128 v[180:183], v36 offset:9216
    v_mfma_f32_16x16x32_bf16 v[236:239], v[84:87], v[196:199], v[236:239]
    ds_read_b128 v[176:179], v36 offset:1024
    s_waitcnt lgkmcnt(10)
    v_mfma_f32_16x16x32_bf16 v[232:235], v[88:91], v[200:203], v[232:235]
    ds_read_b128 v[188:191], v36 offset:10240
    v_mfma_f32_16x16x32_bf16 v[236:239], v[88:91], v[204:207], v[236:239]
    ds_read_b128 v[184:187], v36 offset:2048
    s_waitcnt lgkmcnt(10)
    v_mfma_f32_16x16x32_bf16 v[232:235], v[92:95], v[208:211], v[232:235]
    ds_read_b128 v[196:199], v36 offset:11264
    v_mfma_f32_16x16x32_bf16 v[236:239], v[92:95], v[212:215], v[236:239]
    ds_read_b128 v[192:195], v36 offset:3072
    s_waitcnt lgkmcnt(10)
    v_mfma_f32_16x16x32_bf16 v[232:235], v[96:99], v[216:219], v[232:235]
    ds_read_b128 v[204:207], v36 offset:12288
    v_mfma_f32_16x16x32_bf16 v[236:239], v[96:99], v[220:223], v[236:239]
    ds_read_b128 v[200:203], v36 offset:4096
    s_waitcnt lgkmcnt(10)
    v_mfma_f32_16x16x32_bf16 v[232:235], v[100:103], v[224:227], v[232:235]
    ds_read_b128 v[212:215], v36 offset:13312
    v_mfma_f32_16x16x32_bf16 v[236:239], v[100:103], v[228:231], v[236:239]
    ds_read_b128 v[208:211], v36 offset:5120
    s_add_u32 m0, s90, 81920
    s_add_u32 s89, s81, 8192
    s_andn2_b32 s89, s89, 0x18000
    buffer_load_dwordx4 v36, s[44:47], s89 offen sc1 lds
    buffer_load_dwordx4 v36, s[44:47], s89 offen offset:1024 sc1 lds
    s_waitcnt vmcnt(4)
    buffer_store_dword v8, v9, s[64:67], s94 offen offset:4 sc1
    s_barrier
    s_waitcnt lgkmcnt(10)
    v_mfma_f32_16x16x32_bf16 v[232:235], v[104:107], v[168:171], v[232:235]
    ds_read_b128 v[220:223], v36 offset:14336
    v_mfma_f32_16x16x32_bf16 v[236:239], v[104:107], v[172:175], v[236:239]
    ds_read_b128 v[216:219], v36 offset:6144
    s_waitcnt lgkmcnt(10)
    v_mfma_f32_16x16x32_bf16 v[232:235], v[108:111], v[176:179], v[232:235]
    ds_read_b128 v[228:231], v36 offset:15360
    v_mfma_f32_16x16x32_bf16 v[236:239], v[108:111], v[180:183], v[236:239]
    ds_read_b128 v[224:227], v36 offset:7168
    s_waitcnt lgkmcnt(10)
    v_mfma_f32_16x16x32_bf16 v[232:235], v[112:115], v[184:187], v[232:235]
    ds_read_b128 v[172:175], v36 offset:24576
    v_mfma_f32_16x16x32_bf16 v[236:239], v[112:115], v[188:191], v[236:239]
    ds_read_b128 v[168:171], v36 offset:16384
    s_waitcnt lgkmcnt(10)
    v_mfma_f32_16x16x32_bf16 v[232:235], v[116:119], v[192:195], v[232:235]
    ds_read_b128 v[180:183], v36 offset:25600
    v_mfma_f32_16x16x32_bf16 v[236:239], v[116:119], v[196:199], v[236:239]
    ds_read_b128 v[176:179], v36 offset:17408
    s_waitcnt lgkmcnt(10)
    v_mfma_f32_16x16x32_bf16 v[232:235], v[120:123], v[200:203], v[232:235]
    ds_read_b128 v[188:191], v36 offset:26624
    v_mfma_f32_16x16x32_bf16 v[236:239], v[120:123], v[204:207], v[236:239]
    ds_read_b128 v[184:187], v36 offset:18432
    s_waitcnt lgkmcnt(10)
    v_mfma_f32_16x16x32_bf16 v[232:235], v[124:127], v[208:211], v[232:235]
    ds_read_b128 v[196:199], v36 offset:27648
    v_mfma_f32_16x16x32_bf16 v[236:239], v[124:127], v[212:215], v[236:239]
    ds_read_b128 v[192:195], v36 offset:19456
    s_waitcnt lgkmcnt(10)
    v_mfma_f32_16x16x32_bf16 v[232:235], v[128:131], v[216:219], v[232:235]
    ds_read_b128 v[204:207], v36 offset:28672
    v_mfma_f32_16x16x32_bf16 v[236:239], v[128:131], v[220:223], v[236:239]
    ds_read_b128 v[200:203], v36 offset:20480
    s_waitcnt lgkmcnt(10)
    v_mfma_f32_16x16x32_bf16 v[232:235], v[132:135], v[224:227], v[232:235]
    ds_read_b128 v[212:215], v36 offset:29696
    v_mfma_f32_16x16x32_bf16 v[236:239], v[132:135], v[228:231], v[236:239]
    ds_read_b128 v[208:211], v36 offset:21504
    s_add_u32 m0, s90, 49152
    s_add_u32 s89, s81, 16384
    s_andn2_b32 s89, s89, 0x18000
    buffer_load_dwordx4 v36, s[44:47], s89 offen sc1 lds
    buffer_load_dwordx4 v36, s[44:47], s89 offen offset:1024 sc1 lds
    s_waitcnt vmcnt(5)
    s_barrier
    s_waitcnt lgkmcnt(10)
    v_mfma_f32_16x16x32_bf16 v[232:235], v[136:139], v[168:171], v[232:235]
    ds_read_b128 v[220:223], v36 offset:30720
    v_mfma_f32_16x16x32_bf16 v[236:239], v[136:139], v[172:175], v[236:239]
    ds_read_b128 v[216:219], v36 offset:22528
    s_waitcnt lgkmcnt(10)
    v_mfma_f32_16x16x32_bf16 v[232:235], v[140:143], v[176:179], v[232:235]
    ds_read_b128 v[228:231], v36 offset:31744
    v_mfma_f32_16x16x32_bf16 v[236:239], v[140:143], v[180:183], v[236:239]
    ds_read_b128 v[224:227], v36 offset:23552
    s_waitcnt lgkmcnt(10)
    v_mfma_f32_16x16x32_bf16 v[232:235], v[144:147], v[184:187], v[232:235]
    ds_read_b128 v[172:175], v36 offset:40960
    v_mfma_f32_16x16x32_bf16 v[236:239], v[144:147], v[188:191], v[236:239]
    ds_read_b128 v[168:171], v36 offset:32768
    s_waitcnt lgkmcnt(10)
    v_mfma_f32_16x16x32_bf16 v[232:235], v[148:151], v[192:195], v[232:235]
    ds_read_b128 v[180:183], v36 offset:41984
    v_mfma_f32_16x16x32_bf16 v[236:239], v[148:151], v[196:199], v[236:239]
    ds_read_b128 v[176:179], v36 offset:33792
    s_waitcnt lgkmcnt(10)
    v_mfma_f32_16x16x32_bf16 v[232:235], v[152:155], v[200:203], v[232:235]
    ds_read_b128 v[188:191], v36 offset:43008
    v_mfma_f32_16x16x32_bf16 v[236:239], v[152:155], v[204:207], v[236:239]
    ds_read_b128 v[184:187], v36 offset:34816
    s_waitcnt lgkmcnt(10)
    v_mfma_f32_16x16x32_bf16 v[232:235], v[156:159], v[208:211], v[232:235]
    ds_read_b128 v[196:199], v36 offset:44032
    v_mfma_f32_16x16x32_bf16 v[236:239], v[156:159], v[212:215], v[236:239]
    ds_read_b128 v[192:195], v36 offset:35840
    s_waitcnt lgkmcnt(10)
    v_mfma_f32_16x16x32_bf16 v[232:235], v[160:163], v[216:219], v[232:235]
    ds_read_b128 v[204:207], v36 offset:45056
    v_mfma_f32_16x16x32_bf16 v[236:239], v[160:163], v[220:223], v[236:239]
    ds_read_b128 v[200:203], v36 offset:36864
    s_waitcnt lgkmcnt(10)
    v_mfma_f32_16x16x32_bf16 v[232:235], v[164:167], v[224:227], v[232:235]
    ds_read_b128 v[212:215], v36 offset:46080
    v_mfma_f32_16x16x32_bf16 v[236:239], v[164:167], v[228:231], v[236:239]
    ds_read_b128 v[208:211], v36 offset:37888
    s_add_u32 m0, s90, 65536
    s_add_u32 s89, s81, 24576
    s_andn2_b32 s89, s89, 0x18000
    buffer_load_dwordx4 v36, s[44:47], s89 offen sc1 lds
    buffer_load_dwordx4 v36, s[44:47], s89 offen offset:1024 sc1 lds
    v_cvt_pk_bf16_f32 v28, v232, v233
    v_cvt_pk_bf16_f32 v29, v234, v235
    v_cvt_pk_bf16_f32 v30, v236, v237
    v_cvt_pk_bf16_f32 v31, v238, v239
    v_min_u32 v28, -2, v28
    v_min_u32 v29, -2, v29
    v_min_u32 v30, -2, v30
    v_min_u32 v31, -2, v31
    s_xor_b32 s82, s78, 32768
    buffer_store_dwordx4 v[28:31], v36, s[52:55], s82 offen sc1
    s_waitcnt vmcnt(6)
    s_barrier
    s_waitcnt lgkmcnt(10)
    v_mfma_f32_16x16x32_bf16 v[232:235], v[40:43], v[168:171], 0
    ds_read_b128 v[220:223], v36 offset:47104
    v_mfma_f32_16x16x32_bf16 v[236:239], v[40:43], v[172:175], 0
    ds_read_b128 v[216:219], v36 offset:38912
    s_waitcnt lgkmcnt(10)
    v_mfma_f32_16x16x32_bf16 v[232:235], v[44:47], v[176:179], v[232:235]
    ds_read_b128 v[228:231], v36 offset:48128
    v_mfma_f32_16x16x32_bf16 v[236:239], v[44:47], v[180:183], v[236:239]
    ds_read_b128 v[224:227], v36 offset:39936
    s_waitcnt lgkmcnt(10)
    v_mfma_f32_16x16x32_bf16 v[232:235], v[48:51], v[184:187], v[232:235]
    ds_read_b128 v[172:175], v14 offset:24576
    v_mfma_f32_16x16x32_bf16 v[236:239], v[48:51], v[188:191], v[236:239]
    ds_read_b128 v[168:171], v14 offset:16384
    s_waitcnt lgkmcnt(10)
    v_mfma_f32_16x16x32_bf16 v[232:235], v[52:55], v[192:195], v[232:235]
    ds_read_b128 v[180:183], v14 offset:25600
    v_mfma_f32_16x16x32_bf16 v[236:239], v[52:55], v[196:199], v[236:239]
    ds_read_b128 v[176:179], v14 offset:17408
    s_waitcnt lgkmcnt(10)
    v_mfma_f32_16x16x32_bf16 v[232:235], v[56:59], v[200:203], v[232:235]
    ds_read_b128 v[188:191], v14 offset:26624
    v_mfma_f32_16x16x32_bf16 v[236:239], v[56:59], v[204:207], v[236:239]
    ds_read_b128 v[184:187], v14 offset:18432
    s_waitcnt lgkmcnt(10)
    v_mfma_f32_16x16x32_bf16 v[232:235], v[60:63], v[208:211], v[232:235]
    ds_read_b128 v[196:199], v14 offset:27648
    v_mfma_f32_16x16x32_bf16 v[236:239], v[60:63], v[212:215], v[236:239]
    ds_read_b128 v[192:195], v14 offset:19456
    s_waitcnt lgkmcnt(10)
    v_mfma_f32_16x16x32_bf16 v[232:235], v[64:67], v[216:219], v[232:235]
    ds_read_b128 v[204:207], v14 offset:28672
    v_mfma_f32_16x16x32_bf16 v[236:239], v[64:67], v[220:223], v[236:239]
    ds_read_b128 v[200:203], v14 offset:20480
    s_waitcnt lgkmcnt(10)
    v_mfma_f32_16x16x32_bf16 v[232:235], v[68:71], v[224:227], v[232:235]
    ds_read_b128 v[212:215], v14 offset:29696
    v_mfma_f32_16x16x32_bf16 v[236:239], v[68:71], v[228:231], v[236:239]
    ds_read_b128 v[208:211], v14 offset:21504
    buffer_load_dword v26, v23, s[64:67], s94 offen offset:4 sc1
    s_waitcnt vmcnt(4)
    s_barrier
    s_waitcnt lgkmcnt(10)
    v_mfma_f32_16x16x32_bf16 v[232:235], v[72:75], v[168:171], v[232:235]
    ds_read_b128 v[220:223], v14 offset:30720
    v_mfma_f32_16x16x32_bf16 v[236:239], v[72:75], v[172:175], v[236:239]
    ds_read_b128 v[216:219], v14 offset:22528
    s_waitcnt lgkmcnt(10)
    v_mfma_f32_16x16x32_bf16 v[232:235], v[76:79], v[176:179], v[232:235]
    ds_read_b128 v[228:231], v14 offset:31744
    v_mfma_f32_16x16x32_bf16 v[236:239], v[76:79], v[180:183], v[236:239]
    ds_read_b128 v[224:227], v14 offset:23552
    s_waitcnt lgkmcnt(10)
    v_mfma_f32_16x16x32_bf16 v[232:235], v[80:83], v[184:187], v[232:235]
    ds_read_b128 v[172:175], v36 offset:57344
    v_mfma_f32_16x16x32_bf16 v[236:239], v[80:83], v[188:191], v[236:239]
    ds_read_b128 v[168:171], v36 offset:49152
    s_waitcnt lgkmcnt(10)
    v_mfma_f32_16x16x32_bf16 v[232:235], v[84:87], v[192:195], v[232:235]
    ds_read_b128 v[180:183], v36 offset:58368
    v_mfma_f32_16x16x32_bf16 v[236:239], v[84:87], v[196:199], v[236:239]
    ds_read_b128 v[176:179], v36 offset:50176
    s_waitcnt lgkmcnt(10)
    v_mfma_f32_16x16x32_bf16 v[232:235], v[88:91], v[200:203], v[232:235]
    ds_read_b128 v[188:191], v36 offset:59392
    v_mfma_f32_16x16x32_bf16 v[236:239], v[88:91], v[204:207], v[236:239]
    ds_read_b128 v[184:187], v36 offset:51200
    s_waitcnt lgkmcnt(10)
    v_mfma_f32_16x16x32_bf16 v[232:235], v[92:95], v[208:211], v[232:235]
    ds_read_b128 v[196:199], v36 offset:60416
    v_mfma_f32_16x16x32_bf16 v[236:239], v[92:95], v[212:215], v[236:239]
    ds_read_b128 v[192:195], v36 offset:52224
    s_waitcnt lgkmcnt(10)
    v_mfma_f32_16x16x32_bf16 v[232:235], v[96:99], v[216:219], v[232:235]
    ds_read_b128 v[204:207], v36 offset:61440
    v_mfma_f32_16x16x32_bf16 v[236:239], v[96:99], v[220:223], v[236:239]
    ds_read_b128 v[200:203], v36 offset:53248
    s_waitcnt lgkmcnt(10)
    v_mfma_f32_16x16x32_bf16 v[232:235], v[100:103], v[224:227], v[232:235]
    ds_read_b128 v[212:215], v36 offset:62464
    v_mfma_f32_16x16x32_bf16 v[236:239], v[100:103], v[228:231], v[236:239]
    ds_read_b128 v[208:211], v36 offset:54272
    s_waitcnt vmcnt(0)
    v_cmp_ne_u32 vcc, 1, v26
    s_cbranch_vccz L_flag2a_ok
L_flag2a:
    buffer_load_dword v26, v23, s[64:67], s94 offen offset:4 sc1
    s_add_u32 s98, s98, 0x2000
    s_cbranch_scc1 L_done
    s_waitcnt vmcnt(0)
    v_cmp_ne_u32 vcc, 1, v26
    s_cbranch_vccnz L_flag2a
L_flag2a_ok:
    s_xor_b32 s82, s78, 24576
    buffer_load_dwordx4 v[32:35], v36, s[52:55], s82 offen sc1
    s_xor_b32 s82, s78, 16384
    buffer_load_dwordx4 v[248:251], v36, s[52:55], s82 offen sc1
    s_xor_b32 s82, s78, 8192
    buffer_load_dwordx4 v[4:7], v36, s[52:55], s82 offen sc1
    s_barrier
    s_waitcnt lgkmcnt(10)
    v_mfma_f32_16x16x32_bf16 v[232:235], v[104:107], v[168:171], v[232:235]
    ds_read_b128 v[220:223], v36 offset:63488
    v_mfma_f32_16x16x32_bf16 v[236:239], v[104:107], v[172:175], v[236:239]
    ds_read_b128 v[216:219], v36 offset:55296
    s_waitcnt lgkmcnt(10)
    v_mfma_f32_16x16x32_bf16 v[232:235], v[108:111], v[176:179], v[232:235]
    ds_read_b128 v[228:231], v36 offset:64512
    v_mfma_f32_16x16x32_bf16 v[236:239], v[108:111], v[180:183], v[236:239]
    ds_read_b128 v[224:227], v36 offset:56320
    s_waitcnt lgkmcnt(10)
    v_mfma_f32_16x16x32_bf16 v[232:235], v[112:115], v[184:187], v[232:235]
    ds_read_b128 v[172:175], v14 offset:8192
    v_mfma_f32_16x16x32_bf16 v[236:239], v[112:115], v[188:191], v[236:239]
    ds_read_b128 v[168:171], v14
    s_waitcnt lgkmcnt(10)
    v_mfma_f32_16x16x32_bf16 v[232:235], v[116:119], v[192:195], v[232:235]
    ds_read_b128 v[180:183], v14 offset:9216
    v_mfma_f32_16x16x32_bf16 v[236:239], v[116:119], v[196:199], v[236:239]
    ds_read_b128 v[176:179], v14 offset:1024
    s_waitcnt lgkmcnt(10)
    v_mfma_f32_16x16x32_bf16 v[232:235], v[120:123], v[200:203], v[232:235]
    ds_read_b128 v[188:191], v14 offset:10240
    v_mfma_f32_16x16x32_bf16 v[236:239], v[120:123], v[204:207], v[236:239]
    ds_read_b128 v[184:187], v14 offset:2048
    s_waitcnt lgkmcnt(10)
    v_mfma_f32_16x16x32_bf16 v[232:235], v[124:127], v[208:211], v[232:235]
    ds_read_b128 v[196:199], v14 offset:11264
    v_mfma_f32_16x16x32_bf16 v[236:239], v[124:127], v[212:215], v[236:239]
    ds_read_b128 v[192:195], v14 offset:3072
    s_waitcnt lgkmcnt(10)
    v_mfma_f32_16x16x32_bf16 v[232:235], v[128:131], v[216:219], v[232:235]
    ds_read_b128 v[204:207], v14 offset:12288
    v_mfma_f32_16x16x32_bf16 v[236:239], v[128:131], v[220:223], v[236:239]
    ds_read_b128 v[200:203], v14 offset:4096
    s_waitcnt lgkmcnt(10)
    v_mfma_f32_16x16x32_bf16 v[232:235], v[132:135], v[224:227], v[232:235]
    ds_read_b128 v[212:215], v14 offset:13312
    v_mfma_f32_16x16x32_bf16 v[236:239], v[132:135], v[228:231], v[236:239]
    ds_read_b128 v[208:211], v14 offset:5120
    s_waitcnt lgkmcnt(10)
    v_mfma_f32_16x16x32_bf16 v[232:235], v[136:139], v[168:171], v[232:235]
    ds_read_b128 v[220:223], v14 offset:14336
    v_mfma_f32_16x16x32_bf16 v[236:239], v[136:139], v[172:175], v[236:239]
    ds_read_b128 v[216:219], v14 offset:6144
    s_waitcnt lgkmcnt(10)
    v_mfma_f32_16x16x32_bf16 v[232:235], v[140:143], v[176:179], v[232:235]
    ds_read_b128 v[228:231], v14 offset:15360
    v_mfma_f32_16x16x32_bf16 v[236:239], v[140:143], v[180:183], v[236:239]
    ds_read_b128 v[224:227], v14 offset:7168
    s_waitcnt lgkmcnt(10)
    v_mfma_f32_16x16x32_bf16 v[232:235], v[144:147], v[184:187], v[232:235]
    v_mfma_f32_16x16x32_bf16 v[236:239], v[144:147], v[188:191], v[236:239]
    s_waitcnt lgkmcnt(8)
    v_mfma_f32_16x16x32_bf16 v[232:235], v[148:151], v[192:195], v[232:235]
    v_mfma_f32_16x16x32_bf16 v[236:239], v[148:151], v[196:199], v[236:239]
    s_waitcnt lgkmcnt(6)
    v_mfma_f32_16x16x32_bf16 v[232:235], v[152:155], v[200:203], v[232:235]
    v_mfma_f32_16x16x32_bf16 v[236:239], v[152:155], v[204:207], v[236:239]
    s_waitcnt lgkmcnt(4)
    v_mfma_f32_16x16x32_bf16 v[232:235], v[156:159], v[208:211], v[232:235]
    v_mfma_f32_16x16x32_bf16 v[236:239], v[156:159], v[212:215], v[236:239]
    s_waitcnt lgkmcnt(2)
    v_mfma_f32_16x16x32_bf16 v[232:235], v[160:163], v[216:219], v[232:235]
    v_mfma_f32_16x16x32_bf16 v[236:239], v[160:163], v[220:223], v[236:239]
    s_waitcnt lgkmcnt(0)
    v_mfma_f32_16x16x32_bf16 v[232:235], v[164:167], v[224:227], v[232:235]
    v_mfma_f32_16x16x32_bf16 v[236:239], v[164:167], v[228:231], v[236:239]
    s_waitcnt vmcnt(2)
    v_lshlrev_b32 v240, 16, v32
    v_and_b32 v241, 0xffff0000, v32
    v_lshlrev_b32 v242, 16, v33
    v_and_b32 v243, 0xffff0000, v33
    v_lshlrev_b32 v244, 16, v34
    v_and_b32 v245, 0xffff0000, v34
    v_lshlrev_b32 v246, 16, v35
    v_and_b32 v247, 0xffff0000, v35
    s_waitcnt vmcnt(1)
    v_lshlrev_b32 v2, 16, v248
    v_and_b32 v3, 0xffff0000, v248
    v_add_f32 v240, v2, v240
    v_add_f32 v241, v3, v241
    v_lshlrev_b32 v2, 16, v249
    v_and_b32 v3, 0xffff0000, v249
    v_add_f32 v242, v2, v242
    v_add_f32 v243, v3, v243
    v_lshlrev_b32 v2, 16, v250
    v_and_b32 v3, 0xffff0000, v250
    v_add_f32 v244, v2, v244
    v_add_f32 v245, v3, v245
    v_lshlrev_b32 v2, 16, v251
    v_and_b32 v3, 0xffff0000, v251
    v_add_f32 v246, v2, v246
    v_add_f32 v247, v3, v247
    s_waitcnt vmcnt(0)
    v_max3_u32 v2, v4, v5, v6
    v_max_u32 v2, v7, v2
    v_cmp_eq_u32 vcc, -1, v2
    s_cbranch_vccz L_suma_ok
L_suma:
    s_xor_b32 s82, s78, 8192
    buffer_load_dwordx4 v[4:7], v36, s[52:55], s82 offen sc1
    s_add_u32 s98, s98, 0x2000
    s_cbranch_scc1 L_done
    s_waitcnt vmcnt(0)
    v_max3_u32 v2, v4, v5, v6
    v_max_u32 v2, v7, v2
    v_cmp_eq_u32 vcc, -1, v2
    s_cbranch_vccnz L_suma
L_suma_ok:
    v_lshlrev_b32 v2, 16, v4
    v_and_b32 v3, 0xffff0000, v4
    v_add_f32 v240, v2, v240
    v_add_f32 v241, v3, v241
    v_lshlrev_b32 v2, 16, v5
    v_and_b32 v3, 0xffff0000, v5
    v_add_f32 v242, v2, v242
    v_add_f32 v243, v3, v243
    v_lshlrev_b32 v2, 16, v6
    v_and_b32 v3, 0xffff0000, v6
    v_add_f32 v244, v2, v244
    v_add_f32 v245, v3, v245
    v_lshlrev_b32 v2, 16, v7
L_pad7:
    s_cbranch_execz L_walked
    v_and_b32 v3, 0xffff0000, v7
    v_add_f32 v246, v2, v246
    v_add_f32 v247, v3, v247
    v_add_f32 v232, v240, v232
    v_add_f32 v233, v241, v233
    v_add_f32 v234, v242, v234
    v_add_f32 v235, v243, v235
    v_add_f32 v236, v244, v236
    v_add_f32 v237, v245, v237
    v_add_f32 v238, v246, v238
    v_add_f32 v239, v247, v239
    v_cvt_pk_bf16_f32 v28, v232, v233
    v_cvt_pk_bf16_f32 v29, v234, v235
    v_cvt_pk_bf16_f32 v30, v236, v237
    v_cvt_pk_bf16_f32 v31, v238, v239
    s_nop 0
    v_permlane16_swap_b32 v28, v30
    v_permlane16_swap_b32 v29, v31
    buffer_store_dwordx4 v[28:31], v38, s[56:59], 0 offen
    s_endpgm
L_pad8:
    s_branch L_walked
L_young:
    s_setprio 0
    s_add_u32 m0, s90, 131072
    s_add_u32 s89, s87, 8192
    s_andn2_b32 s89, s89, 0x18000
    buffer_load_dwordx4 v36, s[44:47], s89 offen sc1 lds
    buffer_load_dwordx4 v36, s[44:47], s89 offen offset:1024 sc1 lds
    s_waitcnt lgkmcnt(6)
    v_mfma_f32_16x16x32_bf16 v[232:235], v[40:43], v[168:171], 0
    ds_read_b128 v[204:207], v14 offset:6144
    v_mfma_f32_16x16x32_bf16 v[236:239], v[40:43], v[172:175], 0
    ds_read_b128 v[200:203], v14 offset:2048
    s_waitcnt lgkmcnt(6)
    v_mfma_f32_16x16x32_bf16 v[240:243], v[40:43], v[176:179], 0
    ds_read_b128 v[212:215], v14 offset:14336
    v_mfma_f32_16x16x32_bf16 v[244:247], v[40:43], v[180:183], 0
    ds_read_b128 v[208:211], v14 offset:10240
    s_waitcnt lgkmcnt(6)
    v_mfma_f32_16x16x32_bf16 v[232:235], v[44:47], v[184:187], v[232:235]
    ds_read_b128 v[220:223], v14 offset:7168
    v_mfma_f32_16x16x32_bf16 v[236:239], v[44:47], v[188:191], v[236:239]
    ds_read_b128 v[216:219], v14 offset:3072
    s_waitcnt lgkmcnt(6)
    v_mfma_f32_16x16x32_bf16 v[240:243], v[44:47], v[192:195], v[240:243]
    ds_read_b128 v[228:231], v14 offset:15360
    v_mfma_f32_16x16x32_bf16 v[244:247], v[44:47], v[196:199], v[244:247]
    ds_read_b128 v[224:227], v14 offset:11264
    s_waitcnt vmcnt(4)
    s_setprio 1
    s_barrier
    s_add_u32 m0, s88, 147456
    s_add_u32 s24, s95, 11
    s_and_b32 s24, s24, 15
    s_mul_i32 s27, s24, 81920
    s_add_u32 s24, s27, 0
    buffer_load_dwordx4 v19, s[48:51], s24 offen lds
    s_add_u32 m0, s88, 155648
    s_add_u32 s24, s27, 40960
    buffer_load_dwordx4 v19, s[48:51], s24 offen lds
    s_add_u32 m0, s90, 0
    s_add_u32 s89, s87, 12288
    s_andn2_b32 s89, s89, 0x18000
    buffer_load_dwordx4 v36, s[44:47], s89 offen sc1 lds
    buffer_load_dwordx4 v36, s[44:47], s89 offen offset:1024 sc1 lds
    s_setprio 0
    s_waitcnt lgkmcnt(6)
    v_mfma_f32_16x16x32_bf16 v[232:235], v[48:51], v[200:203], v[232:235]
    ds_read_b128 v[172:175], v14 offset:36864
    v_mfma_f32_16x16x32_bf16 v[236:239], v[48:51], v[204:207], v[236:239]
    ds_read_b128 v[168:171], v14 offset:32768
    s_waitcnt lgkmcnt(6)
    v_mfma_f32_16x16x32_bf16 v[240:243], v[48:51], v[208:211], v[240:243]
    ds_read_b128 v[180:183], v14 offset:45056
    v_mfma_f32_16x16x32_bf16 v[244:247], v[48:51], v[212:215], v[244:247]
    ds_read_b128 v[176:179], v14 offset:40960
    s_waitcnt lgkmcnt(6)
    v_mfma_f32_16x16x32_bf16 v[232:235], v[52:55], v[216:219], v[232:235]
    ds_read_b128 v[188:191], v14 offset:37888
    v_mfma_f32_16x16x32_bf16 v[236:239], v[52:55], v[220:223], v[236:239]
    ds_read_b128 v[184:187], v14 offset:33792
    s_waitcnt lgkmcnt(6)
    v_mfma_f32_16x16x32_bf16 v[240:243], v[52:55], v[224:227], v[240:243]
    ds_read_b128 v[196:199], v14 offset:46080
    v_mfma_f32_16x16x32_bf16 v[244:247], v[52:55], v[228:231], v[244:247]
    ds_read_b128 v[192:195], v14 offset:41984
    s_waitcnt lgkmcnt(6)
    v_mfma_f32_16x16x32_bf16 v[232:235], v[56:59], v[168:171], v[232:235]
    ds_read_b128 v[204:207], v14 offset:38912
    v_mfma_f32_16x16x32_bf16 v[236:239], v[56:59], v[172:175], v[236:239]
    ds_read_b128 v[200:203], v14 offset:34816
    s_waitcnt lgkmcnt(6)
    v_mfma_f32_16x16x32_bf16 v[240:243], v[56:59], v[176:179], v[240:243]
    ds_read_b128 v[212:215], v14 offset:47104
    v_mfma_f32_16x16x32_bf16 v[244:247], v[56:59], v[180:183], v[244:247]
    ds_read_b128 v[208:211], v14 offset:43008
    s_waitcnt lgkmcnt(6)
    v_mfma_f32_16x16x32_bf16 v[232:235], v[60:63], v[184:187], v[232:235]
    ds_read_b128 v[220:223], v14 offset:39936
    v_mfma_f32_16x16x32_bf16 v[236:239], v[60:63], v[188:191], v[236:239]
    ds_read_b128 v[216:219], v14 offset:35840
    s_waitcnt lgkmcnt(6)
    v_mfma_f32_16x16x32_bf16 v[240:243], v[60:63], v[192:195], v[240:243]
    ds_read_b128 v[228:231], v14 offset:48128
    v_mfma_f32_16x16x32_bf16 v[244:247], v[60:63], v[196:199], v[244:247]
    ds_read_b128 v[224:227], v14 offset:44032
    s_waitcnt vmcnt(4)
    s_setprio 1
    s_barrier
    s_add_u32 m0, s88, 16384
    s_add_u32 s24, s95, 12
    s_and_b32 s24, s24, 15
    s_mul_i32 s27, s24, 81920
    s_add_u32 s24, s27, 0
    buffer_load_dwordx4 v19, s[48:51], s24 offen lds
    s_add_u32 m0, s88, 24576
    s_add_u32 s24, s27, 40960
    buffer_load_dwordx4 v19, s[48:51], s24 offen lds
    s_add_u32 m0, s90, 32768
    s_add_u32 s89, s87, 16384
    s_andn2_b32 s89, s89, 0x18000
    buffer_load_dwordx4 v36, s[44:47], s89 offen sc1 lds
    buffer_load_dwordx4 v36, s[44:47], s89 offen offset:1024 sc1 lds
    s_setprio 0
    s_waitcnt lgkmcnt(6)
    v_mfma_f32_16x16x32_bf16 v[232:235], v[64:67], v[200:203], v[232:235]
    ds_read_b128 v[172:175], v15 offset:4096
    ds_read_b64_tr_b16 v[120:121], v11 offset:49152
    v_mfma_f32_16x16x32_bf16 v[236:239], v[64:67], v[204:207], v[236:239]
    ds_read_b128 v[168:171], v15
    s_waitcnt lgkmcnt(7)
    v_mfma_f32_16x16x32_bf16 v[240:243], v[64:67], v[208:211], v[240:243]
    ds_read_b128 v[180:183], v15 offset:12288
    ds_read_b64_tr_b16 v[122:123], v11 offset:53248
    v_mfma_f32_16x16x32_bf16 v[244:247], v[64:67], v[212:215], v[244:247]
    ds_read_b128 v[176:179], v15 offset:8192
    s_waitcnt lgkmcnt(8)
    v_mfma_f32_16x16x32_bf16 v[232:235], v[68:71], v[216:219], v[232:235]
    ds_read_b128 v[188:191], v15 offset:5120
    ds_read_b64_tr_b16 v[124:125], v11 offset:57344
    v_mfma_f32_16x16x32_bf16 v[236:239], v[68:71], v[220:223], v[236:239]
    ds_read_b128 v[184:187], v15 offset:1024
    s_waitcnt lgkmcnt(9)
    v_mfma_f32_16x16x32_bf16 v[240:243], v[68:71], v[224:227], v[240:243]
    ds_read_b128 v[196:199], v15 offset:13312
    ds_read_b64_tr_b16 v[126:127], v11 offset:61440
    v_mfma_f32_16x16x32_bf16 v[244:247], v[68:71], v[228:231], v[244:247]
    ds_read_b128 v[192:195], v15 offset:9216
    s_waitcnt lgkmcnt(9)
    v_mfma_f32_16x16x32_bf16 v[232:235], v[72:75], v[168:171], v[232:235]
    ds_read_b128 v[204:207], v15 offset:6144
    v_mfma_f32_16x16x32_bf16 v[236:239], v[72:75], v[172:175], v[236:239]
    ds_read_b128 v[200:203], v15 offset:2048
    s_waitcnt lgkmcnt(8)
    v_mfma_f32_16x16x32_bf16 v[240:243], v[72:75], v[176:179], v[240:243]
    ds_read_b128 v[212:215], v15 offset:14336
    v_mfma_f32_16x16x32_bf16 v[244:247], v[72:75], v[180:183], v[244:247]
    ds_read_b128 v[208:211], v15 offset:10240
    s_waitcnt lgkmcnt(7)
    v_mfma_f32_16x16x32_bf16 v[232:235], v[76:79], v[184:187], v[232:235]
    ds_read_b128 v[220:223], v15 offset:7168
    v_mfma_f32_16x16x32_bf16 v[236:239], v[76:79], v[188:191], v[236:239]
    ds_read_b128 v[216:219], v15 offset:3072
    s_waitcnt lgkmcnt(6)
    v_mfma_f32_16x16x32_bf16 v[240:243], v[76:79], v[192:195], v[240:243]
    ds_read_b128 v[228:231], v15 offset:15360
    v_mfma_f32_16x16x32_bf16 v[244:247], v[76:79], v[196:199], v[244:247]
    ds_read_b128 v[224:227], v15 offset:11264
    s_waitcnt vmcnt(4)
    s_setprio 1
    s_barrier
    s_add_u32 m0, s88, 81920
    s_add_u32 s24, s95, 13
    s_and_b32 s24, s24, 15
    s_mul_i32 s27, s24, 81920
    s_add_u32 s24, s27, 0
    buffer_load_dwordx4 v19, s[48:51], s24 offen lds
    s_add_u32 m0, s88, 90112
    s_add_u32 s24, s27, 40960
    buffer_load_dwordx4 v19, s[48:51], s24 offen lds
    s_add_u32 m0, s90, 49152
    s_add_u32 s89, s87, 20480
    s_andn2_b32 s89, s89, 0x18000
    buffer_load_dwordx4 v36, s[44:47], s89 offen sc1 lds
    buffer_load_dwordx4 v36, s[44:47], s89 offen offset:1024 sc1 lds
    s_setprio 0
    s_waitcnt lgkmcnt(6)
    v_mfma_f32_16x16x32_bf16 v[232:235], v[80:83], v[200:203], v[232:235]
    ds_read_b128 v[172:175], v36 offset:4096
    ds_read_b64_tr_b16 v[128:129], v12 offset:16384
    v_mfma_f32_16x16x32_bf16 v[236:239], v[80:83], v[204:207], v[236:239]
    ds_read_b128 v[168:171], v36
    s_waitcnt lgkmcnt(7)
    v_mfma_f32_16x16x32_bf16 v[240:243], v[80:83], v[208:211], v[240:243]
    ds_read_b128 v[180:183], v36 offset:12288
    ds_read_b64_tr_b16 v[130:131], v12 offset:20480
    v_mfma_f32_16x16x32_bf16 v[244:247], v[80:83], v[212:215], v[244:247]
    ds_read_b128 v[176:179], v36 offset:8192
    s_waitcnt lgkmcnt(8)
    v_mfma_f32_16x16x32_bf16 v[232:235], v[84:87], v[216:219], v[232:235]
    ds_read_b128 v[188:191], v36 offset:5120
    ds_read_b64_tr_b16 v[132:133], v12 offset:24576
    v_mfma_f32_16x16x32_bf16 v[236:239], v[84:87], v[220:223], v[236:239]
    ds_read_b128 v[184:187], v36 offset:1024
    s_waitcnt lgkmcnt(9)
    v_mfma_f32_16x16x32_bf16 v[240:243], v[84:87], v[224:227], v[240:243]
    ds_read_b128 v[196:199], v36 offset:13312
    ds_read_b64_tr_b16 v[134:135], v12 offset:28672
    v_mfma_f32_16x16x32_bf16 v[244:247], v[84:87], v[228:231], v[244:247]
    ds_read_b128 v[192:195], v36 offset:9216
    s_waitcnt lgkmcnt(9)
    v_mfma_f32_16x16x32_bf16 v[232:235], v[88:91], v[168:171], v[232:235]
    ds_read_b128 v[204:207], v36 offset:6144
    v_mfma_f32_16x16x32_bf16 v[236:239], v[88:91], v[172:175], v[236:239]
    ds_read_b128 v[200:203], v36 offset:2048
    s_waitcnt lgkmcnt(8)
    v_mfma_f32_16x16x32_bf16 v[240:243], v[88:91], v[176:179], v[240:243]
    ds_read_b128 v[212:215], v36 offset:14336
    v_mfma_f32_16x16x32_bf16 v[244:247], v[88:91], v[180:183], v[244:247]
    ds_read_b128 v[208:211], v36 offset:10240
    s_waitcnt lgkmcnt(7)
    v_mfma_f32_16x16x32_bf16 v[232:235], v[92:95], v[184:187], v[232:235]
    ds_read_b128 v[220:223], v36 offset:7168
    v_mfma_f32_16x16x32_bf16 v[236:239], v[92:95], v[188:191], v[236:239]
    ds_read_b128 v[216:219], v36 offset:3072
    s_waitcnt lgkmcnt(6)
    v_mfma_f32_16x16x32_bf16 v[240:243], v[92:95], v[192:195], v[240:243]
    ds_read_b128 v[228:231], v36 offset:15360
    v_mfma_f32_16x16x32_bf16 v[244:247], v[92:95], v[196:199], v[244:247]
    ds_read_b128 v[224:227], v36 offset:11264
    s_waitcnt vmcnt(4)
    s_setprio 1
    s_barrier
    s_add_u32 m0, s88, 65536
    s_add_u32 s24, s95, 14
    s_and_b32 s24, s24, 15
    s_mul_i32 s27, s24, 81920
    s_add_u32 s24, s27, 0
    buffer_load_dwordx4 v19, s[48:51], s24 offen lds
    s_add_u32 m0, s88, 73728
    s_add_u32 s24, s27, 40960
    buffer_load_dwordx4 v19, s[48:51], s24 offen lds
    buffer_load_dword v26, v21, s[64:67], s91 offen sc1
    s_add_u32 m0, s90, 98304
    s_add_u32 s89, s87, 24576
    s_andn2_b32 s89, s89, 0x18000
    buffer_load_dwordx4 v36, s[44:47], s89 offen sc1 lds
    buffer_load_dwordx4 v36, s[44:47], s89 offen offset:1024 sc1 lds
    s_setprio 0
    s_waitcnt lgkmcnt(6)
    v_mfma_f32_16x16x32_bf16 v[232:235], v[96:99], v[200:203], v[232:235]
    ds_read_b128 v[172:175], v36 offset:36864
    ds_read_b64_tr_b16 v[136:137], v10 offset:16384
    v_mfma_f32_16x16x32_bf16 v[236:239], v[96:99], v[204:207], v[236:239]
    ds_read_b128 v[168:171], v36 offset:32768
    s_waitcnt lgkmcnt(7)
    v_mfma_f32_16x16x32_bf16 v[240:243], v[96:99], v[208:211], v[240:243]
    ds_read_b128 v[180:183], v36 offset:45056
    ds_read_b64_tr_b16 v[138:139], v10 offset:20480
    v_mfma_f32_16x16x32_bf16 v[244:247], v[96:99], v[212:215], v[244:247]
    ds_read_b128 v[176:179], v36 offset:40960
    s_waitcnt lgkmcnt(8)
    v_mfma_f32_16x16x32_bf16 v[232:235], v[100:103], v[216:219], v[232:235]
    ds_read_b128 v[188:191], v36 offset:37888
    ds_read_b64_tr_b16 v[140:141], v10 offset:24576
    v_mfma_f32_16x16x32_bf16 v[236:239], v[100:103], v[220:223], v[236:239]
    ds_read_b128 v[184:187], v36 offset:33792
    s_waitcnt lgkmcnt(9)
    v_mfma_f32_16x16x32_bf16 v[240:243], v[100:103], v[224:227], v[240:243]
    ds_read_b128 v[196:199], v36 offset:46080
    ds_read_b64_tr_b16 v[142:143], v10 offset:28672
    v_mfma_f32_16x16x32_bf16 v[244:247], v[100:103], v[228:231], v[244:247]
    ds_read_b128 v[192:195], v36 offset:41984
    s_waitcnt lgkmcnt(9)
    v_mfma_f32_16x16x32_bf16 v[232:235], v[104:107], v[168:171], v[232:235]
    ds_read_b128 v[204:207], v36 offset:38912
    v_mfma_f32_16x16x32_bf16 v[236:239], v[104:107], v[172:175], v[236:239]
    ds_read_b128 v[200:203], v36 offset:34816
    s_waitcnt lgkmcnt(8)
    v_mfma_f32_16x16x32_bf16 v[240:243], v[104:107], v[176:179], v[240:243]
    ds_read_b128 v[212:215], v36 offset:47104
    v_mfma_f32_16x16x32_bf16 v[244:247], v[104:107], v[180:183], v[244:247]
    ds_read_b128 v[208:211], v36 offset:43008
    s_waitcnt lgkmcnt(7)
    v_mfma_f32_16x16x32_bf16 v[232:235], v[108:111], v[184:187], v[232:235]
    ds_read_b128 v[220:223], v36 offset:39936
    v_mfma_f32_16x16x32_bf16 v[236:239], v[108:111], v[188:191], v[236:239]
    ds_read_b128 v[216:219], v36 offset:35840
    s_waitcnt lgkmcnt(6)
    v_mfma_f32_16x16x32_bf16 v[240:243], v[108:111], v[192:195], v[240:243]
    ds_read_b128 v[228:231], v36 offset:48128
    v_mfma_f32_16x16x32_bf16 v[244:247], v[108:111], v[196:199], v[244:247]
    ds_read_b128 v[224:227], v36 offset:44032
    s_waitcnt vmcnt(5)
    s_setprio 1
    s_barrier
    s_add_u32 m0, s90, 114688
    s_add_u32 s89, s87, 28672
    s_andn2_b32 s89, s89, 0x18000
    buffer_load_dwordx4 v36, s[44:47], s89 offen sc1 lds
    buffer_load_dwordx4 v36, s[44:47], s89 offen offset:1024 sc1 lds
    s_waitcnt vmcnt(4)
    v_cmp_ne_u32 vcc, 1, v26
    s_cbranch_vccz L_restb_ok
L_restb:
    buffer_load_dword v26, v21, s[64:67], s91 offen sc1
    s_add_u32 s98, s98, 0x2000
    s_cbranch_scc1 L_done
    s_waitcnt vmcnt(0)
    v_cmp_ne_u32 vcc, 1, v26
    s_cbranch_vccz L_restb_ok
    s_and_b32 s24, s98, 0xe000
    s_cbranch_scc1 L_restb
    buffer_load_dword v26, v22, s[64:67], 0 offen sc1
    s_waitcnt vmcnt(0)
    v_cmp_ne_u32 vcc, 1, v26
    s_cbranch_vccnz L_restb
L_restb_ok:
    s_add_u32 m0, s90, 131072
    s_add_u32 s89, s81, 0
    s_andn2_b32 s89, s89, 0x18000
    s_xor_b32 s89, s89, 262144
    buffer_load_dwordx4 v36, s[44:47], s89 offen sc1 lds
    buffer_load_dwordx4 v36, s[44:47], s89 offen offset:1024 sc1 lds
    s_setprio 0
    s_waitcnt lgkmcnt(6)
    v_mfma_f32_16x16x32_bf16 v[232:235], v[112:115], v[200:203], v[232:235]
    ds_read_b128 v[172:175], v36 offset:53248
    ds_read_b64_tr_b16 v[144:145], v11 offset:16384
    v_mfma_f32_16x16x32_bf16 v[236:239], v[112:115], v[204:207], v[236:239]
    ds_read_b128 v[168:171], v36 offset:49152
    s_waitcnt lgkmcnt(7)
    v_mfma_f32_16x16x32_bf16 v[240:243], v[112:115], v[208:211], v[240:243]
    ds_read_b128 v[180:183], v36 offset:61440
    ds_read_b64_tr_b16 v[146:147], v11 offset:20480
    v_mfma_f32_16x16x32_bf16 v[244:247], v[112:115], v[212:215], v[244:247]
    ds_read_b128 v[176:179], v36 offset:57344
    s_waitcnt lgkmcnt(8)
    v_mfma_f32_16x16x32_bf16 v[232:235], v[116:119], v[216:219], v[232:235]
    ds_read_b128 v[188:191], v36 offset:54272
    ds_read_b64_tr_b16 v[148:149], v11 offset:24576
    v_mfma_f32_16x16x32_bf16 v[236:239], v[116:119], v[220:223], v[236:239]
    ds_read_b128 v[184:187], v36 offset:50176
    s_waitcnt lgkmcnt(9)
    v_mfma_f32_16x16x32_bf16 v[240:243], v[116:119], v[224:227], v[240:243]
    ds_read_b128 v[196:199], v36 offset:62464
    ds_read_b64_tr_b16 v[150:151], v11 offset:28672
    v_mfma_f32_16x16x32_bf16 v[244:247], v[116:119], v[228:231], v[244:247]
    ds_read_b128 v[192:195], v36 offset:58368
    s_waitcnt lgkmcnt(9)
    v_mfma_f32_16x16x32_bf16 v[232:235], v[120:123], v[168:171], v[232:235]
    ds_read_b128 v[204:207], v36 offset:55296
    v_mfma_f32_16x16x32_bf16 v[236:239], v[120:123], v[172:175], v[236:239]
    ds_read_b128 v[200:203], v36 offset:51200
    s_waitcnt lgkmcnt(8)
    v_mfma_f32_16x16x32_bf16 v[240:243], v[120:123], v[176:179], v[240:243]
    ds_read_b128 v[212:215], v36 offset:63488
    v_mfma_f32_16x16x32_bf16 v[244:247], v[120:123], v[180:183], v[244:247]
    ds_read_b128 v[208:211], v36 offset:59392
    s_waitcnt lgkmcnt(7)
    v_mfma_f32_16x16x32_bf16 v[232:235], v[124:127], v[184:187], v[232:235]
    ds_read_b128 v[220:223], v36 offset:56320
    v_mfma_f32_16x16x32_bf16 v[236:239], v[124:127], v[188:191], v[236:239]
    ds_read_b128 v[216:219], v36 offset:52224
    s_waitcnt lgkmcnt(6)
    v_mfma_f32_16x16x32_bf16 v[240:243], v[124:127], v[192:195], v[240:243]
    ds_read_b128 v[228:231], v36 offset:64512
    v_mfma_f32_16x16x32_bf16 v[244:247], v[124:127], v[196:199], v[244:247]
    ds_read_b128 v[224:227], v36 offset:60416
    s_waitcnt vmcnt(4)
    s_setprio 1
    s_barrier
    s_add_u32 m0, s90, 147456
    s_add_u32 s89, s81, 8192
    s_andn2_b32 s89, s89, 0x18000
    s_xor_b32 s89, s89, 262144
    buffer_load_dwordx4 v36, s[44:47], s89 offen sc1 lds
    buffer_load_dwordx4 v36, s[44:47], s89 offen offset:1024 sc1 lds
    s_setprio 0
    s_waitcnt lgkmcnt(6)
    v_mfma_f32_16x16x32_bf16 v[232:235], v[128:131], v[200:203], v[232:235]
    ds_read_b128 v[172:175], v14 offset:36864
    ds_read_b64_tr_b16 v[152:153], v11
    v_mfma_f32_16x16x32_bf16 v[236:239], v[128:131], v[204:207], v[236:239]
    ds_read_b128 v[168:171], v14 offset:32768
    s_waitcnt lgkmcnt(7)
    v_mfma_f32_16x16x32_bf16 v[240:243], v[128:131], v[208:211], v[240:243]
    ds_read_b128 v[180:183], v14 offset:45056
    ds_read_b64_tr_b16 v[154:155], v11 offset:4096
    v_mfma_f32_16x16x32_bf16 v[244:247], v[128:131], v[212:215], v[244:247]
    ds_read_b128 v[176:179], v14 offset:40960
    s_waitcnt lgkmcnt(8)
    v_mfma_f32_16x16x32_bf16 v[232:235], v[132:135], v[216:219], v[232:235]
    ds_read_b128 v[188:191], v14 offset:37888
    ds_read_b64_tr_b16 v[156:157], v11 offset:8192
    v_mfma_f32_16x16x32_bf16 v[236:239], v[132:135], v[220:223], v[236:239]
    ds_read_b128 v[184:187], v14 offset:33792
    s_waitcnt lgkmcnt(9)
    v_mfma_f32_16x16x32_bf16 v[240:243], v[132:135], v[224:227], v[240:243]
    ds_read_b128 v[196:199], v14 offset:46080
    ds_read_b64_tr_b16 v[158:159], v11 offset:12288
    v_mfma_f32_16x16x32_bf16 v[244:247], v[132:135], v[228:231], v[244:247]
    ds_read_b128 v[192:195], v14 offset:41984
    s_waitcnt lgkmcnt(9)
    v_mfma_f32_16x16x32_bf16 v[232:235], v[136:139], v[168:171], v[232:235]
    ds_read_b128 v[204:207], v14 offset:38912
    v_mfma_f32_16x16x32_bf16 v[236:239], v[136:139], v[172:175], v[236:239]
    ds_read_b128 v[200:203], v14 offset:34816
    s_waitcnt lgkmcnt(8)
    v_mfma_f32_16x16x32_bf16 v[240:243], v[136:139], v[176:179], v[240:243]
    ds_read_b128 v[212:215], v14 offset:47104
    v_mfma_f32_16x16x32_bf16 v[244:247], v[136:139], v[180:183], v[244:247]
    ds_read_b128 v[208:211], v14 offset:43008
    s_waitcnt vmcnt(4)
    s_setprio 1
    s_barrier
    s_xor_b32 s82, s78, 32768
    buffer_store_dwordx4 v[32:35], v36, s[52:55], s82 offen sc1
    s_add_u32 m0, s90, 0
    s_add_u32 s89, s81, 16384
    s_andn2_b32 s89, s89, 0x18000
    s_xor_b32 s89, s89, 262144
    buffer_load_dwordx4 v36, s[44:47], s89 offen sc1 lds
    buffer_load_dwordx4 v36, s[44:47], s89 offen offset:1024 sc1 lds
    s_setprio 0
    s_waitcnt lgkmcnt(7)
    v_mfma_f32_16x16x32_bf16 v[232:235], v[140:143], v[184:187], v[232:235]
    ds_read_b128 v[220:223], v14 offset:39936
    ds_read_b128 v[216:219], v14 offset:35840
    v_mfma_f32_16x16x32_bf16 v[236:239], v[140:143], v[188:191], v[236:239]
    ds_read_b128 v[228:231], v14 offset:48128
    ds_read_b128 v[224:227], v14 offset:44032
    s_waitcnt lgkmcnt(8)
    v_mfma_f32_16x16x32_bf16 v[240:243], v[140:143], v[192:195], v[240:243]
    ds_read_b128 v[172:175], v14 offset:53248
    ds_read_b128 v[168:171], v14 offset:49152
    v_mfma_f32_16x16x32_bf16 v[244:247], v[140:143], v[196:199], v[244:247]
    ds_read_b128 v[180:183], v14 offset:61440
    ds_read_b128 v[176:179], v14 offset:57344
    s_waitcnt lgkmcnt(10)
    v_mfma_f32_16x16x32_bf16 v[232:235], v[144:147], v[200:203], v[232:235]
    ds_read_b128 v[188:191], v14 offset:54272
    v_mfma_f32_16x16x32_bf16 v[236:239], v[144:147], v[204:207], v[236:239]
    ds_read_b128 v[184:187], v14 offset:50176
    s_waitcnt lgkmcnt(10)
    v_mfma_f32_16x16x32_bf16 v[240:243], v[144:147], v[208:211], v[240:243]
    ds_read_b128 v[196:199], v14 offset:62464
    v_mfma_f32_16x16x32_bf16 v[244:247], v[144:147], v[212:215], v[244:247]
    ds_read_b128 v[192:195], v14 offset:58368
    s_waitcnt lgkmcnt(10)
    v_mfma_f32_16x16x32_bf16 v[232:235], v[148:151], v[216:219], v[232:235]
    ds_read_b128 v[204:207], v14 offset:55296
    v_mfma_f32_16x16x32_bf16 v[236:239], v[148:151], v[220:223], v[236:239]
    ds_read_b128 v[200:203], v14 offset:51200
    s_waitcnt lgkmcnt(10)
    v_mfma_f32_16x16x32_bf16 v[240:243], v[148:151], v[224:227], v[240:243]
    ds_read_b128 v[212:215], v14 offset:63488
    v_mfma_f32_16x16x32_bf16 v[244:247], v[148:151], v[228:231], v[244:247]
    ds_read_b128 v[208:211], v14 offset:59392
    s_waitcnt vmcnt(5)
    s_setprio 1
    s_barrier
    s_add_u32 m0, s90, 16384
    s_add_u32 s89, s81, 24576
    s_andn2_b32 s89, s89, 0x18000
    s_xor_b32 s89, s89, 262144
    buffer_load_dwordx4 v36, s[44:47], s89 offen sc1 lds
    buffer_load_dwordx4 v36, s[44:47], s89 offen offset:1024 sc1 lds
    s_setprio 0
    s_waitcnt lgkmcnt(10)
    v_mfma_f32_16x16x32_bf16 v[232:235], v[152:155], v[168:171], v[232:235]
    ds_read_b128 v[220:223], v14 offset:56320
    v_mfma_f32_16x16x32_bf16 v[236:239], v[152:155], v[172:175], v[236:239]
    ds_read_b128 v[216:219], v14 offset:52224
    s_waitcnt lgkmcnt(10)
    v_mfma_f32_16x16x32_bf16 v[240:243], v[152:155], v[176:179], v[240:243]
    ds_read_b128 v[228:231], v14 offset:64512
    v_mfma_f32_16x16x32_bf16 v[244:247], v[152:155], v[180:183], v[244:247]
    ds_read_b128 v[224:227], v14 offset:60416
    s_waitcnt lgkmcnt(10)
    v_mfma_f32_16x16x32_bf16 v[232:235], v[156:159], v[184:187], v[232:235]
    ds_read_b128 v[172:175], v15 offset:8192
    v_mfma_f32_16x16x32_bf16 v[236:239], v[156:159], v[188:191], v[236:239]
    ds_read_b128 v[168:171], v15
    s_waitcnt lgkmcnt(10)
    v_mfma_f32_16x16x32_bf16 v[240:243], v[156:159], v[192:195], v[240:243]
    ds_read_b128 v[180:183], v15 offset:9216
    v_mfma_f32_16x16x32_bf16 v[244:247], v[156:159], v[196:199], v[244:247]
    ds_read_b128 v[176:179], v15 offset:1024
    s_waitcnt lgkmcnt(10)
    v_mfma_f32_16x16x32_bf16 v[232:235], v[160:163], v[200:203], v[232:235]
    ds_read_b128 v[188:191], v15 offset:10240
    v_mfma_f32_16x16x32_bf16 v[236:239], v[160:163], v[204:207], v[236:239]
    ds_read_b128 v[184:187], v15 offset:2048
    s_waitcnt lgkmcnt(10)
    v_mfma_f32_16x16x32_bf16 v[240:243], v[160:163], v[208:211], v[240:243]
    ds_read_b128 v[196:199], v15 offset:11264
    v_mfma_f32_16x16x32_bf16 v[244:247], v[160:163], v[212:215], v[244:247]
    ds_read_b128 v[192:195], v15 offset:3072
    s_waitcnt lgkmcnt(10)
    v_mfma_f32_16x16x32_bf16 v[232:235], v[164:167], v[216:219], v[232:235]
    ds_read_b128 v[204:207], v15 offset:12288
    v_mfma_f32_16x16x32_bf16 v[236:239], v[164:167], v[220:223], v[236:239]
    ds_read_b128 v[200:203], v15 offset:4096
    s_waitcnt lgkmcnt(10)
    v_mfma_f32_16x16x32_bf16 v[240:243], v[164:167], v[224:227], v[240:243]
    ds_read_b128 v[212:215], v15 offset:13312
    v_mfma_f32_16x16x32_bf16 v[244:247], v[164:167], v[228:231], v[244:247]
    ds_read_b128 v[208:211], v15 offset:5120
    s_waitcnt vmcnt(5)
    s_setprio 1
    s_barrier
    v_cvt_pk_bf16_f32 v28, v232, v233
    v_cvt_pk_bf16_f32 v29, v234, v235
    v_cvt_pk_bf16_f32 v30, v236, v237
    v_cvt_pk_bf16_f32 v31, v238, v239
    s_xor_b32 s82, s78, 98304
    buffer_store_dwordx4 v[28:31], v36, s[52:55], s82 offen sc1
    s_nop 1
    v_cvt_pk_bf16_f32 v28, v240, v241
    v_cvt_pk_bf16_f32 v29, v242, v243
    v_cvt_pk_bf16_f32 v30, v244, v245
    v_cvt_pk_bf16_f32 v31, v246, v247
    s_xor_b32 s82, s78, 65536
    buffer_store_dwordx4 v[28:31], v36, s[52:55], s82 offen sc1
    s_add_u32 m0, s90, 32768
    s_add_u32 s89, s81, 0
    s_andn2_b32 s89, s89, 0x18000
    buffer_load_dwordx4 v36, s[44:47], s89 offen sc1 lds
    buffer_load_dwordx4 v36, s[44:47], s89 offen offset:1024 sc1 lds
    s_setprio 0
    s_waitcnt lgkmcnt(10)
    v_mfma_f32_16x16x32_bf16 v[232:235], v[40:43], v[168:171], 0
    ds_read_b128 v[220:223], v15 offset:14336
    v_mfma_f32_16x16x32_bf16 v[236:239], v[40:43], v[172:175], 0
    ds_read_b128 v[216:219], v15 offset:6144
    s_waitcnt lgkmcnt(10)
    v_mfma_f32_16x16x32_bf16 v[232:235], v[44:47], v[176:179], v[232:235]
    ds_read_b128 v[228:231], v15 offset:15360
    v_mfma_f32_16x16x32_bf16 v[236:239], v[44:47], v[180:183], v[236:239]
    ds_read_b128 v[224:227], v15 offset:7168
    s_waitcnt lgkmcnt(10)
    v_mfma_f32_16x16x32_bf16 v[232:235], v[48:51], v[184:187], v[232:235]
    ds_read_b128 v[172:175], v15 offset:24576
    v_mfma_f32_16x16x32_bf16 v[236:239], v[48:51], v[188:191], v[236:239]
    ds_read_b128 v[168:171], v15 offset:16384
    s_waitcnt lgkmcnt(10)
    v_mfma_f32_16x16x32_bf16 v[232:235], v[52:55], v[192:195], v[232:235]
    ds_read_b128 v[180:183], v15 offset:25600
    v_mfma_f32_16x16x32_bf16 v[236:239], v[52:55], v[196:199], v[236:239]
    ds_read_b128 v[176:179], v15 offset:17408
    s_waitcnt lgkmcnt(10)
    v_mfma_f32_16x16x32_bf16 v[232:235], v[56:59], v[200:203], v[232:235]
    ds_read_b128 v[188:191], v15 offset:26624
    v_mfma_f32_16x16x32_bf16 v[236:239], v[56:59], v[204:207], v[236:239]
    ds_read_b128 v[184:187], v15 offset:18432
    s_waitcnt lgkmcnt(10)
    v_mfma_f32_16x16x32_bf16 v[232:235], v[60:63], v[208:211], v[232:235]
    ds_read_b128 v[196:199], v15 offset:27648
    v_mfma_f32_16x16x32_bf16 v[236:239], v[60:63], v[212:215], v[236:239]
    ds_read_b128 v[192:195], v15 offset:19456
    s_waitcnt lgkmcnt(10)
    v_mfma_f32_16x16x32_bf16 v[232:235], v[64:67], v[216:219], v[232:235]
    ds_read_b128 v[204:207], v15 offset:28672
    v_mfma_f32_16x16x32_bf16 v[236:239], v[64:67], v[220:223], v[236:239]
    ds_read_b128 v[200:203], v15 offset:20480
    s_waitcnt lgkmcnt(10)
    v_mfma_f32_16x16x32_bf16 v[232:235], v[68:71], v[224:227], v[232:235]
    ds_read_b128 v[212:215], v15 offset:29696
    v_mfma_f32_16x16x32_bf16 v[236:239], v[68:71], v[228:231], v[236:239]
    ds_read_b128 v[208:211], v15 offset:21504
    s_waitcnt vmcnt(6)
    s_setprio 1
    s_barrier
    s_add_u32 m0, s90, 81920
    s_add_u32 s89, s81, 8192
    s_andn2_b32 s89, s89, 0x18000
    buffer_load_dwordx4 v36, s[44:47], s89 offen sc1 lds
    buffer_load_dwordx4 v36, s[44:47], s89 offen offset:1024 sc1 lds
    s_setprio 0
    s_waitcnt lgkmcnt(10)
    v_mfma_f32_16x16x32_bf16 v[232:235], v[72:75], v[168:171], v[232:235]
    ds_read_b128 v[220:223], v15 offset:30720
    v_mfma_f32_16x16x32_bf16 v[236:239], v[72:75], v[172:175], v[236:239]
    ds_read_b128 v[216:219], v15 offset:22528
    s_waitcnt lgkmcnt(10)
    v_mfma_f32_16x16x32_bf16 v[232:235], v[76:79], v[176:179], v[232:235]
    ds_read_b128 v[228:231], v15 offset:31744
    v_mfma_f32_16x16x32_bf16 v[236:239], v[76:79], v[180:183], v[236:239]
    ds_read_b128 v[224:227], v15 offset:23552
    s_waitcnt lgkmcnt(10)
    v_mfma_f32_16x16x32_bf16 v[232:235], v[80:83], v[184:187], v[232:235]
    ds_read_b128 v[172:175], v36 offset:8192
    v_mfma_f32_16x16x32_bf16 v[236:239], v[80:83], v[188:191], v[236:239]
L_pad9:
    s_cbranch_execz L_walked
    ds_read_b128 v[168:171], v36
    s_waitcnt lgkmcnt(10)
    v_mfma_f32_16x16x32_bf16 v[232:235], v[84:87], v[192:195], v[232:235]
    ds_read_b128 v[180:183], v36 offset:9216
    v_mfma_f32_16x16x32_bf16 v[236:239], v[84:87], v[196:199], v[236:239]
    ds_read_b128 v[176:179], v36 offset:1024
    s_waitcnt lgkmcnt(10)
    v_mfma_f32_16x16x32_bf16 v[232:235], v[88:91], v[200:203], v[232:235]
    ds_read_b128 v[188:191], v36 offset:10240
    v_mfma_f32_16x16x32_bf16 v[236:239], v[88:91], v[204:207], v[236:239]
    ds_read_b128 v[184:187], v36 offset:2048
    s_waitcnt lgkmcnt(10)
    v_mfma_f32_16x16x32_bf16 v[232:235], v[92:95], v[208:211], v[232:235]
    ds_read_b128 v[196:199], v36 offset:11264
    v_mfma_f32_16x16x32_bf16 v[236:239], v[92:95], v[212:215], v[236:239]
    ds_read_b128 v[192:195], v36 offset:3072
    s_waitcnt lgkmcnt(10)
    v_mfma_f32_16x16x32_bf16 v[232:235], v[96:99], v[216:219], v[232:235]
    ds_read_b128 v[204:207], v36 offset:12288
    v_mfma_f32_16x16x32_bf16 v[236:239], v[96:99], v[220:223], v[236:239]
    ds_read_b128 v[200:203], v36 offset:4096
    s_waitcnt lgkmcnt(10)
    v_mfma_f32_16x16x32_bf16 v[232:235], v[100:103], v[224:227], v[232:235]
    ds_read_b128 v[212:215], v36 offset:13312
    v_mfma_f32_16x16x32_bf16 v[236:239], v[100:103], v[228:231], v[236:239]
    ds_read_b128 v[208:211], v36 offset:5120
    s_waitcnt vmcnt(6)
    s_setprio 1
    s_barrier
    s_waitcnt vmcnt(4)
    buffer_store_dword v8, v9, s[64:67], s94 offen offset:4 sc1
    s_add_u32 m0, s90, 49152
    s_add_u32 s89, s81, 16384
    s_andn2_b32 s89, s89, 0x18000
    buffer_load_dwordx4 v36, s[44:47], s89 offen sc1 lds
    buffer_load_dwordx4 v36, s[44:47], s89 offen offset:1024 sc1 lds
    s_setprio 0
    s_waitcnt lgkmcnt(10)
    v_mfma_f32_16x16x32_bf16 v[232:235], v[104:107], v[168:171], v[232:235]
    ds_read_b128 v[220:223], v36 offset:14336
    v_mfma_f32_16x16x32_bf16 v[236:239], v[104:107], v[172:175], v[236:239]
    ds_read_b128 v[216:219], v36 offset:6144
    s_waitcnt lgkmcnt(10)
    v_mfma_f32_16x16x32_bf16 v[232:235], v[108:111], v[176:179], v[232:235]
    ds_read_b128 v[228:231], v36 offset:15360
    v_mfma_f32_16x16x32_bf16 v[236:239], v[108:111], v[180:183], v[236:239]
    ds_read_b128 v[224:227], v36 offset:7168
    s_waitcnt lgkmcnt(10)
    v_mfma_f32_16x16x32_bf16 v[232:235], v[112:115], v[184:187], v[232:235]
    ds_read_b128 v[172:175], v36 offset:24576
    v_mfma_f32_16x16x32_bf16 v[236:239], v[112:115], v[188:191], v[236:239]
    ds_read_b128 v[168:171], v36 offset:16384
    s_waitcnt lgkmcnt(10)
    v_mfma_f32_16x16x32_bf16 v[232:235], v[116:119], v[192:195], v[232:235]
    ds_read_b128 v[180:183], v36 offset:25600
    v_mfma_f32_16x16x32_bf16 v[236:239], v[116:119], v[196:199], v[236:239]
    ds_read_b128 v[176:179], v36 offset:17408
    s_waitcnt lgkmcnt(10)
    v_mfma_f32_16x16x32_bf16 v[232:235], v[120:123], v[200:203], v[232:235]
    ds_read_b128 v[188:191], v36 offset:26624
    v_mfma_f32_16x16x32_bf16 v[236:239], v[120:123], v[204:207], v[236:239]
    ds_read_b128 v[184:187], v36 offset:18432
    s_waitcnt lgkmcnt(10)
    v_mfma_f32_16x16x32_bf16 v[232:235], v[124:127], v[208:211], v[232:235]
    ds_read_b128 v[196:199], v36 offset:27648
    v_mfma_f32_16x16x32_bf16 v[236:239], v[124:127], v[212:215], v[236:239]
    ds_read_b128 v[192:195], v36 offset:19456
    s_waitcnt lgkmcnt(10)
    v_mfma_f32_16x16x32_bf16 v[232:235], v[128:131], v[216:219], v[232:235]
    ds_read_b128 v[204:207], v36 offset:28672
    v_mfma_f32_16x16x32_bf16 v[236:239], v[128:131], v[220:223], v[236:239]
    ds_read_b128 v[200:203], v36 offset:20480
    s_waitcnt lgkmcnt(10)
    v_mfma_f32_16x16x32_bf16 v[232:235], v[132:135], v[224:227], v[232:235]
    ds_read_b128 v[212:215], v36 offset:29696
    v_mfma_f32_16x16x32_bf16 v[236:239], v[132:135], v[228:231], v[236:239]
    ds_read_b128 v[208:211], v36 offset:21504
    s_waitcnt vmcnt(5)
    s_setprio 1
    s_barrier
    s_add_u32 m0, s90, 65536
    s_add_u32 s89, s81, 24576
    s_andn2_b32 s89, s89, 0x18000
    buffer_load_dwordx4 v36, s[44:47], s89 offen sc1 lds
    buffer_load_dwordx4 v36, s[44:47], s89 offen offset:1024 sc1 lds
    s_setprio 0
    s_waitcnt lgkmcnt(10)
    v_mfma_f32_16x16x32_bf16 v[232:235], v[136:139], v[168:171], v[232:235]
    ds_read_b128 v[220:223], v36 offset:30720
    v_mfma_f32_16x16x32_bf16 v[236:239], v[136:139], v[172:175], v[236:239]
    ds_read_b128 v[216:219], v36 offset:22528
    s_waitcnt lgkmcnt(10)
    v_mfma_f32_16x16x32_bf16 v[232:235], v[140:143], v[176:179], v[232:235]
    ds_read_b128 v[228:231], v36 offset:31744
    v_mfma_f32_16x16x32_bf16 v[236:239], v[140:143], v[180:183], v[236:239]
    ds_read_b128 v[224:227], v36 offset:23552
    s_waitcnt lgkmcnt(10)
    v_mfma_f32_16x16x32_bf16 v[232:235], v[144:147], v[184:187], v[232:235]
    ds_read_b128 v[172:175], v36 offset:40960
    v_mfma_f32_16x16x32_bf16 v[236:239], v[144:147], v[188:191], v[236:239]
    ds_read_b128 v[168:171], v36 offset:32768
    s_waitcnt lgkmcnt(10)
    v_mfma_f32_16x16x32_bf16 v[232:235], v[148:151], v[192:195], v[232:235]
    ds_read_b128 v[180:183], v36 offset:41984
    v_mfma_f32_16x16x32_bf16 v[236:239], v[148:151], v[196:199], v[236:239]
    ds_read_b128 v[176:179], v36 offset:33792
    s_waitcnt lgkmcnt(10)
    v_mfma_f32_16x16x32_bf16 v[232:235], v[152:155], v[200:203], v[232:235]
    ds_read_b128 v[188:191], v36 offset:43008
    v_mfma_f32_16x16x32_bf16 v[236:239], v[152:155], v[204:207], v[236:239]
    ds_read_b128 v[184:187], v36 offset:34816
    s_waitcnt lgkmcnt(10)
    v_mfma_f32_16x16x32_bf16 v[232:235], v[156:159], v[208:211], v[232:235]
    ds_read_b128 v[196:199], v36 offset:44032
    v_mfma_f32_16x16x32_bf16 v[236:239], v[156:159], v[212:215], v[236:239]
    ds_read_b128 v[192:195], v36 offset:35840
    s_waitcnt lgkmcnt(10)
    v_mfma_f32_16x16x32_bf16 v[232:235], v[160:163], v[216:219], v[232:235]
    ds_read_b128 v[204:207], v36 offset:45056
    v_mfma_f32_16x16x32_bf16 v[236:239], v[160:163], v[220:223], v[236:239]
    ds_read_b128 v[200:203], v36 offset:36864
    s_waitcnt lgkmcnt(10)
    v_mfma_f32_16x16x32_bf16 v[232:235], v[164:167], v[224:227], v[232:235]
    ds_read_b128 v[212:215], v36 offset:46080
    v_mfma_f32_16x16x32_bf16 v[236:239], v[164:167], v[228:231], v[236:239]
    ds_read_b128 v[208:211], v36 offset:37888
    s_waitcnt vmcnt(5)
    s_setprio 1
    s_barrier
    s_nop 1
    v_cvt_pk_bf16_f32 v28, v232, v233
    v_cvt_pk_bf16_f32 v29, v234, v235
    v_cvt_pk_bf16_f32 v30, v236, v237
    v_cvt_pk_bf16_f32 v31, v238, v239
    v_min_u32 v28, -2, v28
    v_min_u32 v29, -2, v29
    v_min_u32 v30, -2, v30
    v_min_u32 v31, -2, v31
    s_xor_b32 s82, s78, 32768
    buffer_store_dwordx4 v[28:31], v36, s[52:55], s82 offen sc1
    s_setprio 0
    s_waitcnt lgkmcnt(10)
    v_mfma_f32_16x16x32_bf16 v[232:235], v[40:43], v[168:171], 0
    ds_read_b128 v[220:223], v36 offset:47104
    v_mfma_f32_16x16x32_bf16 v[236:239], v[40:43], v[172:175], 0
    ds_read_b128 v[216:219], v36 offset:38912
    s_waitcnt lgkmcnt(10)
    v_mfma_f32_16x16x32_bf16 v[232:235], v[44:47], v[176:179], v[232:235]
    ds_read_b128 v[228:231], v36 offset:48128
    v_mfma_f32_16x16x32_bf16 v[236:239], v[44:47], v[180:183], v[236:239]
    ds_read_b128 v[224:227], v36 offset:39936
    s_waitcnt lgkmcnt(10)
    v_mfma_f32_16x16x32_bf16 v[232:235], v[48:51], v[184:187], v[232:235]
    ds_read_b128 v[172:175], v14 offset:24576
    v_mfma_f32_16x16x32_bf16 v[236:239], v[48:51], v[188:191], v[236:239]
    ds_read_b128 v[168:171], v14 offset:16384
    s_waitcnt lgkmcnt(10)
    v_mfma_f32_16x16x32_bf16 v[232:235], v[52:55], v[192:195], v[232:235]
    ds_read_b128 v[180:183], v14 offset:25600
    v_mfma_f32_16x16x32_bf16 v[236:239], v[52:55], v[196:199], v[236:239]
    ds_read_b128 v[176:179], v14 offset:17408
    s_waitcnt lgkmcnt(10)
    v_mfma_f32_16x16x32_bf16 v[232:235], v[56:59], v[200:203], v[232:235]
    ds_read_b128 v[188:191], v14 offset:26624
    v_mfma_f32_16x16x32_bf16 v[236:239], v[56:59], v[204:207], v[236:239]
    ds_read_b128 v[184:187], v14 offset:18432
    s_waitcnt lgkmcnt(10)
    v_mfma_f32_16x16x32_bf16 v[232:235], v[60:63], v[208:211], v[232:235]
    ds_read_b128 v[196:199], v14 offset:27648
    v_mfma_f32_16x16x32_bf16 v[236:239], v[60:63], v[212:215], v[236:239]
    ds_read_b128 v[192:195], v14 offset:19456
    s_waitcnt lgkmcnt(10)
    v_mfma_f32_16x16x32_bf16 v[232:235], v[64:67], v[216:219], v[232:235]
    ds_read_b128 v[204:207], v14 offset:28672
    v_mfma_f32_16x16x32_bf16 v[236:239], v[64:67], v[220:223], v[236:239]
    ds_read_b128 v[200:203], v14 offset:20480
    s_waitcnt lgkmcnt(10)
    v_mfma_f32_16x16x32_bf16 v[232:235], v[68:71], v[224:227], v[232:235]
    ds_read_b128 v[212:215], v14 offset:29696
    v_mfma_f32_16x16x32_bf16 v[236:239], v[68:71], v[228:231], v[236:239]
    ds_read_b128 v[208:211], v14 offset:21504
    s_waitcnt vmcnt(3)
    s_setprio 1
    s_barrier
    buffer_load_dword v26, v23, s[64:67], s94 offen offset:4 sc1
    s_setprio 0
    s_waitcnt lgkmcnt(10)
    v_mfma_f32_16x16x32_bf16 v[232:235], v[72:75], v[168:171], v[232:235]
    ds_read_b128 v[220:223], v14 offset:30720
    v_mfma_f32_16x16x32_bf16 v[236:239], v[72:75], v[172:175], v[236:239]
    ds_read_b128 v[216:219], v14 offset:22528
    s_waitcnt lgkmcnt(10)
    v_mfma_f32_16x16x32_bf16 v[232:235], v[76:79], v[176:179], v[232:235]
    ds_read_b128 v[228:231], v14 offset:31744
    v_mfma_f32_16x16x32_bf16 v[236:239], v[76:79], v[180:183], v[236:239]
    ds_read_b128 v[224:227], v14 offset:23552
    s_waitcnt lgkmcnt(10)
    v_mfma_f32_16x16x32_bf16 v[232:235], v[80:83], v[184:187], v[232:235]
    ds_read_b128 v[172:175], v36 offset:57344
    v_mfma_f32_16x16x32_bf16 v[236:239], v[80:83], v[188:191], v[236:239]
    ds_read_b128 v[168:171], v36 offset:49152
    s_waitcnt lgkmcnt(10)
    v_mfma_f32_16x16x32_bf16 v[232:235], v[84:87], v[192:195], v[232:235]
    ds_read_b128 v[180:183], v36 offset:58368
    v_mfma_f32_16x16x32_bf16 v[236:239], v[84:87], v[196:199], v[236:239]
    ds_read_b128 v[176:179], v36 offset:50176
    s_waitcnt lgkmcnt(10)
    v_mfma_f32_16x16x32_bf16 v[232:235], v[88:91], v[200:203], v[232:235]
    ds_read_b128 v[188:191], v36 offset:59392
    v_mfma_f32_16x16x32_bf16 v[236:239], v[88:91], v[204:207], v[236:239]
    ds_read_b128 v[184:187], v36 offset:51200
    s_waitcnt lgkmcnt(10)
    v_mfma_f32_16x16x32_bf16 v[232:235], v[92:95], v[208:211], v[232:235]
    ds_read_b128 v[196:199], v36 offset:60416
    v_mfma_f32_16x16x32_bf16 v[236:239], v[92:95], v[212:215], v[236:239]
    ds_read_b128 v[192:195], v36 offset:52224
    s_waitcnt lgkmcnt(10)
    v_mfma_f32_16x16x32_bf16 v[232:235], v[96:99], v[216:219], v[232:235]
    ds_read_b128 v[204:207], v36 offset:61440
    v_mfma_f32_16x16x32_bf16 v[236:239], v[96:99], v[220:223], v[236:239]
    ds_read_b128 v[200:203], v36 offset:53248
    s_waitcnt lgkmcnt(10)
    v_mfma_f32_16x16x32_bf16 v[232:235], v[100:103], v[224:227], v[232:235]
    ds_read_b128 v[212:215], v36 offset:62464
    v_mfma_f32_16x16x32_bf16 v[236:239], v[100:103], v[228:231], v[236:239]
    ds_read_b128 v[208:211], v36 offset:54272
    s_waitcnt vmcnt(2)
    s_setprio 1
    s_barrier
    s_waitcnt vmcnt(0)
    v_cmp_ne_u32 vcc, 1, v26
    s_cbranch_vccz L_flag2b_ok
L_flag2b:
    buffer_load_dword v26, v23, s[64:67], s94 offen offset:4 sc1
    s_add_u32 s98, s98, 0x2000
    s_cbranch_scc1 L_done
    s_waitcnt vmcnt(0)
    v_cmp_ne_u32 vcc, 1, v26
    s_cbranch_vccnz L_flag2b
L_flag2b_ok:
    s_xor_b32 s82, s78, 24576
    buffer_load_dwordx4 v[32:35], v36, s[52:55], s82 offen sc1
    s_xor_b32 s82, s78, 16384
    buffer_load_dwordx4 v[248:251], v36, s[52:55], s82 offen sc1
    s_xor_b32 s82, s78, 8192
    buffer_load_dwordx4 v[4:7], v36, s[52:55], s82 offen sc1
    s_setprio 0
    s_waitcnt lgkmcnt(10)
    v_mfma_f32_16x16x32_bf16 v[232:235], v[104:107], v[168:171], v[232:235]
    ds_read_b128 v[220:223], v36 offset:63488
    v_mfma_f32_16x16x32_bf16 v[236:239], v[104:107], v[172:175], v[236:239]
    ds_read_b128 v[216:219], v36 offset:55296
    s_waitcnt lgkmcnt(10)
    v_mfma_f32_16x16x32_bf16 v[232:235], v[108:111], v[176:179], v[232:235]
    ds_read_b128 v[228:231], v36 offset:64512
    v_mfma_f32_16x16x32_bf16 v[236:239], v[108:111], v[180:183], v[236:239]
    ds_read_b128 v[224:227], v36 offset:56320
    s_waitcnt lgkmcnt(10)
    v_mfma_f32_16x16x32_bf16 v[232:235], v[112:115], v[184:187], v[232:235]
    ds_read_b128 v[172:175], v14 offset:8192
    v_mfma_f32_16x16x32_bf16 v[236:239], v[112:115], v[188:191], v[236:239]
    ds_read_b128 v[168:171], v14
    s_waitcnt lgkmcnt(10)
    v_mfma_f32_16x16x32_bf16 v[232:235], v[116:119], v[192:195], v[232:235]
    ds_read_b128 v[180:183], v14 offset:9216
    v_mfma_f32_16x16x32_bf16 v[236:239], v[116:119], v[196:199], v[236:239]
    ds_read_b128 v[176:179], v14 offset:1024
    s_waitcnt lgkmcnt(10)
    v_mfma_f32_16x16x32_bf16 v[232:235], v[120:123], v[200:203], v[232:235]
    ds_read_b128 v[188:191], v14 offset:10240
    v_mfma_f32_16x16x32_bf16 v[236:239], v[120:123], v[204:207], v[236:239]
    ds_read_b128 v[184:187], v14 offset:2048
    s_waitcnt lgkmcnt(10)
    v_mfma_f32_16x16x32_bf16 v[232:235], v[124:127], v[208:211], v[232:235]
    ds_read_b128 v[196:199], v14 offset:11264
    v_mfma_f32_16x16x32_bf16 v[236:239], v[124:127], v[212:215], v[236:239]
    ds_read_b128 v[192:195], v14 offset:3072
    s_waitcnt lgkmcnt(10)
    v_mfma_f32_16x16x32_bf16 v[232:235], v[128:131], v[216:219], v[232:235]
    ds_read_b128 v[204:207], v14 offset:12288
    v_mfma_f32_16x16x32_bf16 v[236:239], v[128:131], v[220:223], v[236:239]
    ds_read_b128 v[200:203], v14 offset:4096
    s_waitcnt lgkmcnt(10)
    v_mfma_f32_16x16x32_bf16 v[232:235], v[132:135], v[224:227], v[232:235]
    ds_read_b128 v[212:215], v14 offset:13312
    v_mfma_f32_16x16x32_bf16 v[236:239], v[132:135], v[228:231], v[236:239]
    ds_read_b128 v[208:211], v14 offset:5120
    s_waitcnt lgkmcnt(10)
    v_mfma_f32_16x16x32_bf16 v[232:235], v[136:139], v[168:171], v[232:235]
    ds_read_b128 v[220:223], v14 offset:14336
    v_mfma_f32_16x16x32_bf16 v[236:239], v[136:139], v[172:175], v[236:239]
    ds_read_b128 v[216:219], v14 offset:6144
    s_waitcnt lgkmcnt(10)
    v_mfma_f32_16x16x32_bf16 v[232:235], v[140:143], v[176:179], v[232:235]
    ds_read_b128 v[228:231], v14 offset:15360
    v_mfma_f32_16x16x32_bf16 v[236:239], v[140:143], v[180:183], v[236:239]
    ds_read_b128 v[224:227], v14 offset:7168
    s_waitcnt lgkmcnt(10)
    v_mfma_f32_16x16x32_bf16 v[232:235], v[144:147], v[184:187], v[232:235]
    v_mfma_f32_16x16x32_bf16 v[236:239], v[144:147], v[188:191], v[236:239]
    s_waitcnt lgkmcnt(8)
    v_mfma_f32_16x16x32_bf16 v[232:235], v[148:151], v[192:195], v[232:235]
    v_mfma_f32_16x16x32_bf16 v[236:239], v[148:151], v[196:199], v[236:239]
    s_waitcnt lgkmcnt(6)
    v_mfma_f32_16x16x32_bf16 v[232:235], v[152:155], v[200:203], v[232:235]
    v_mfma_f32_16x16x32_bf16 v[236:239], v[152:155], v[204:207], v[236:239]
    s_waitcnt lgkmcnt(4)
    v_mfma_f32_16x16x32_bf16 v[232:235], v[156:159], v[208:211], v[232:235]
    v_mfma_f32_16x16x32_bf16 v[236:239], v[156:159], v[212:215], v[236:239]
    s_waitcnt lgkmcnt(2)
    v_mfma_f32_16x16x32_bf16 v[232:235], v[160:163], v[216:219], v[232:235]
    v_mfma_f32_16x16x32_bf16 v[236:239], v[160:163], v[220:223], v[236:239]
    s_waitcnt lgkmcnt(0)
    v_mfma_f32_16x16x32_bf16 v[232:235], v[164:167], v[224:227], v[232:235]
    v_mfma_f32_16x16x32_bf16 v[236:239], v[164:167], v[228:231], v[236:239]
    s_waitcnt vmcnt(2)
    v_lshlrev_b32 v240, 16, v32
    v_and_b32 v241, 0xffff0000, v32
    v_lshlrev_b32 v242, 16, v33
    v_and_b32 v243, 0xffff0000, v33
    v_lshlrev_b32 v244, 16, v34
    v_and_b32 v245, 0xffff0000, v34
    v_lshlrev_b32 v246, 16, v35
    v_and_b32 v247, 0xffff0000, v35
    s_waitcnt vmcnt(1)
    v_lshlrev_b32 v2, 16, v248
    v_and_b32 v3, 0xffff0000, v248
    v_add_f32 v240, v2, v240
    v_add_f32 v241, v3, v241
    v_lshlrev_b32 v2, 16, v249
    v_and_b32 v3, 0xffff0000, v249
    v_add_f32 v242, v2, v242
    v_add_f32 v243, v3, v243
    v_lshlrev_b32 v2, 16, v250
    v_and_b32 v3, 0xffff0000, v250
    v_add_f32 v244, v2, v244
    v_add_f32 v245, v3, v245
    v_lshlrev_b32 v2, 16, v251
    v_and_b32 v3, 0xffff0000, v251
    v_add_f32 v246, v2, v246
    v_add_f32 v247, v3, v247
    s_waitcnt vmcnt(0)
    v_max3_u32 v2, v4, v5, v6
    v_max_u32 v2, v7, v2
    v_cmp_eq_u32 vcc, -1, v2
    s_cbranch_vccz L_sumb_ok
L_sumb:
    s_xor_b32 s82, s78, 8192
    buffer_load_dwordx4 v[4:7], v36, s[52:55], s82 offen sc1
    s_add_u32 s98, s98, 0x2000
    s_cbranch_scc1 L_done
    s_waitcnt vmcnt(0)
    v_max3_u32 v2, v4, v5, v6
    v_max_u32 v2, v7, v2
    v_cmp_eq_u32 vcc, -1, v2
    s_cbranch_vccnz L_sumb
L_sumb_ok:
    v_lshlrev_b32 v2, 16, v4
    v_and_b32 v3, 0xffff0000, v4
    v_add_f32 v240, v2, v240
    v_add_f32 v241, v3, v241
    v_lshlrev_b32 v2, 16, v5
    v_and_b32 v3, 0xffff0000, v5
    v_add_f32 v242, v2, v242
    v_add_f32 v243, v3, v243
    v_lshlrev_b32 v2, 16, v6
    v_and_b32 v3, 0xffff0000, v6
    v_add_f32 v244, v2, v244
    v_add_f32 v245, v3, v245
    v_lshlrev_b32 v2, 16, v7
    v_and_b32 v3, 0xffff0000, v7
    v_add_f32 v246, v2, v246
    v_add_f32 v247, v3, v247
    v_add_f32 v232, v240, v232
    v_add_f32 v233, v241, v233
    v_add_f32 v234, v242, v234
    v_add_f32 v235, v243, v235
    v_add_f32 v236, v244, v236
    v_add_f32 v237, v245, v237
    v_add_f32 v238, v246, v238
    v_add_f32 v239, v247, v239
    v_cvt_pk_bf16_f32 v28, v232, v233
    v_cvt_pk_bf16_f32 v29, v234, v235
    v_cvt_pk_bf16_f32 v30, v236, v237
    v_cvt_pk_bf16_f32 v31, v238, v239
    s_nop 0
    v_permlane16_swap_b32 v28, v30
    v_permlane16_swap_b32 v29, v31
    buffer_store_dwordx4 v[28:31], v38, s[56:59], 0 offen
L_done:
L_exit:
    s_endpgm
L_end:
.if L_end-L_compute < 33024
.fill (33024-(L_end-L_compute))/4, 4, 0xbf810000
.endif
L_fin:
.section .rodata,"a"
.p2align 6
.amdhsa_kernel concat_heads__mha_block_cached__gqa_block_cached__near_ridge_kernel
  .amdhsa_next_free_vgpr 256
  .amdhsa_next_free_sgpr 102
  .amdhsa_accum_offset 256
  .amdhsa_group_segment_fixed_size 0
  .amdhsa_kernarg_size 104
  .amdhsa_user_sgpr_count 2
  .amdhsa_user_sgpr_kernarg_segment_ptr 1
  .amdhsa_system_sgpr_workgroup_id_x 1
.end_amdhsa_kernel
```
